```python
import torch

def _softmax(x, axis=-1):
    return torch.softmax(x, dim=axis)
def _gelu(x):
    return torch.nn.functional.gelu(x, approximate="tanh")
def _silu(x):
    return torch.nn.functional.silu(x)
def _sigmoid(x):
    return torch.sigmoid(x)
def _layernorm(x, axis=-1, eps=1e-5):
    m = x.mean(dim=axis, keepdim=True)
    v = x.var(dim=axis, keepdim=True, unbiased=False)
    return (x - m) / torch.sqrt(v + eps)
def _scatter_add(tgt, idx, src, axis=0):
    return tgt.clone().index_add_(axis, idx, src)
def _segment_sum(src, seg, n):
    out = torch.zeros((n,) + src.shape[1:], dtype=src.dtype)
    return out.index_add_(0, seg, src)
def _pad(x, pw):
    flat = tuple(v for pair in reversed(pw) for v in pair)
    return torch.nn.functional.pad(x, flat)

kernel_name = 'parallel_sum__spectral_gfnet__glu_gated_bilinear__prompt'

def setup_inputs():

    _w = (lambda a: (lambda t: t.to(torch.bfloat16) if t.is_floating_point() else t)(torch.as_tensor(a)))
    def _A_setup():
        B, S, D = 1, 2048, 640
        Df = D // 2 + 1
        return {
            "x": _w((lambda *s: torch.randn(*s, dtype=torch.bfloat16) * 0.05)(B, S, D)),
            "w_r": _w((lambda *s: torch.randn(*s, dtype=torch.bfloat16) * 0.4)(S, Df) * 0.02),
            "w_i": _w((lambda *s: torch.randn(*s, dtype=torch.bfloat16) * 0.4)(S, Df) * 0.02),
        }
    _A_in = _A_setup()

    def _B_setup():
        B, S, D, F = 1, 2048, 640, 1728
        return {
            "x": _w((lambda *s: torch.randn(*s, dtype=torch.bfloat16) * 0.05)(B, S, D)),
            "w_gate": _w((lambda *s: torch.randn(*s, dtype=torch.bfloat16) * 0.2)(D, F) * (D ** -0.5)),
            "w_up": _w((lambda *s: torch.randn(*s, dtype=torch.bfloat16) * 0.2)(D, F) * (D ** -0.5)),
            "w_down": _w((lambda *s: torch.randn(*s, dtype=torch.bfloat16) * 0.2)(F, D) * (F ** -0.5)),
        }
    _B_in = _B_setup()

    return {
        "A_x": _A_in["x"],
        "A_w_r": _A_in["w_r"],
        "A_w_i": _A_in["w_i"],
        "B_x": _B_in["x"],
        "B_w_gate": _B_in["w_gate"],
        "B_w_up": _B_in["w_up"],
        "B_w_down": _B_in["w_down"],
    }

def reference(A_x, A_w_r, A_w_i, B_x, B_w_gate, B_w_up, B_w_down):
    def _A_ref(x, w_r, w_i):
        B, S, D = x.shape
        X = (lambda x, axes=(-2,-1): torch.fft.rfft2(x.float(), dim=axes))(x, axes=(-2, -1))
        W = w_r + 1j * w_i
        X = X * W
        y = (lambda x, s, axes=(-2,-1): torch.fft.irfft2(x, s=s, dim=axes).to(torch.bfloat16))(X, (S, D), axes=(-2, -1))
        return y

    def _B_ref(x, w_gate, w_up, w_down):
        g = torch.einsum("bsd,df->bsf", x, w_gate)
        u = torch.einsum("bsd,df->bsf", x, w_up)
        h = g * u
        return torch.einsum("bsf,fd->bsd", h, w_down)

    x = A_x
    xn = _layernorm(x, axis=-1)
    return x + _A_ref(xn, A_w_r, A_w_i) + _B_ref(xn, B_w_gate, B_w_up, B_w_down)
```

```asm
; @launch grid=(256,1,1) block=(512,1,1) lds=163840
.amdgcn_target "amdgcn-amd-amdhsa--gfx950"
.text
.globl parallel_sum__spectral_gfnet__glu_gated_bilinear__prompt_kernel
.p2align 8
.type parallel_sum__spectral_gfnet__glu_gated_bilinear__prompt_kernel,@function
parallel_sum__spectral_gfnet__glu_gated_bilinear__prompt_kernel:
s_cmp_ge_u32 s2, 256
s_cbranch_scc1 K_END
s_load_dwordx4 s[56:59], s[0:1], 0
s_load_dwordx2 s[60:61], s[0:1], 16
s_load_dwordx4 s[64:67], s[0:1], 32
s_load_dwordx2 s[68:69], s[0:1], 48
s_load_dwordx4 s[72:75], s[0:1], 64
s_load_dwordx2 s[82:83], s[0:1], 56
v_and_b32 v1, 63, v0
v_lshrrev_b32 v2, 6, v0
s_and_b32 s3, s2, 7
s_lshr_b32 s4, s2, 3
v_readfirstlane_b32 s40, v2
s_and_b32 s5, s3, 1
s_lshl_b32 s5, s5, 2
s_and_b32 s6, s4, 3
s_add_u32 s41, s5, s6
s_lshr_b32 s5, s3, 1
s_lshl_b32 s5, s5, 3
s_lshr_b32 s6, s4, 2
s_add_u32 s42, s5, s6
s_lshr_b32 s43, s40, 1
s_and_b32 s44, s40, 1
s_lshl_b32 s49, s40, 12
s_lshl_b32 s50, s40, 10
s_add_u32 s50, s50, 98304
s_waitcnt lgkmcnt(0)
s_mov_b32 s8, s56
s_and_b32 s9, s57, 0xffff
s_mov_b32 s10, 2621440
s_mov_b32 s11, 0x20000
s_mov_b32 s28, s58
s_and_b32 s29, s59, 0xffff
s_mov_b32 s30, 1314816
s_mov_b32 s31, 0x20000
s_mov_b32 s32, s60
s_and_b32 s33, s61, 0xffff
s_mov_b32 s34, 1314816
s_mov_b32 s35, 0x20000
s_mov_b32 s12, s64
s_and_b32 s13, s65, 0xffff
s_mov_b32 s14, 2211840
s_mov_b32 s15, 0x20000
s_mov_b32 s16, s66
s_and_b32 s17, s67, 0xffff
s_mov_b32 s18, 2211840
s_mov_b32 s19, 0x20000
s_mov_b32 s24, s68
s_and_b32 s25, s69, 0xffff
s_mov_b32 s26, 2211840
s_mov_b32 s27, 0x20000
s_mov_b32 s36, s72
s_and_b32 s37, s73, 0xffff
s_mov_b32 s38, 256
s_mov_b32 s39, 0x20000
s_mov_b32 s20, s74
s_and_b32 s21, s75, 0xffff
s_mov_b32 s22, 23068672
s_mov_b32 s23, 0x20000
s_cmp_ge_u32 s42, 27
s_cbranch_scc1 K1_DFT
v_and_b32 v2, 7, v1
v_lshrrev_b32 v3, 4, v1
v_xor_b32 v2, v2, v3
v_lshlrev_b32 v2, 4, v2
v_lshrrev_b32 v4, 3, v1
v_mul_u32_u24 v4, 1280, v4
v_add_u32 v16, v4, v2
s_lshl_b32 s52, s41, 8
s_lshl_b32 s53, s40, 5
s_add_u32 s52, s52, s53
s_mul_i32 s45, s52, 1280
s_add_u32 s46, s45, 10240
s_add_u32 s47, s45, 20480
s_add_u32 s48, s45, 30720
v_bfe_u32 v4, v1, 4, 1
s_and_b32 s52, s40, 1
s_lshl_b32 s52, s52, 1
v_or_b32 v4, s52, v4
v_lshlrev_b32 v4, 1, v4
v_and_b32 v5, 7, v1
v_xor_b32 v4, v4, v5
v_lshlrev_b32 v4, 4, v4
v_lshrrev_b32 v5, 3, v1
s_lshl_b32 s52, s40, 3
v_add_u32 v5, s52, v5
v_mul_u32_u24 v5, 3456, v5
s_lshl_b32 s52, s42, 7
v_add3_u32 v18, v5, v4, s52
v_xor_b32 v17, 64, v16
s_add_u32 m0, s49, 0
s_add_u32 s52, s45, 0
buffer_load_dwordx4 v16, s[8:11], s52 offen lds
s_add_u32 m0, s49, 1024
s_add_u32 s52, s46, 0
buffer_load_dwordx4 v17, s[8:11], s52 offen lds
s_add_u32 m0, s49, 2048
s_add_u32 s52, s47, 0
buffer_load_dwordx4 v16, s[8:11], s52 offen lds
s_add_u32 m0, s49, 3072
s_add_u32 s52, s48, 0
buffer_load_dwordx4 v17, s[8:11], s52 offen lds
s_add_u32 m0, s50, 0
s_mov_b32 s52, 0
buffer_load_dwordx4 v18, s[12:15], s52 offen lds
s_add_u32 m0, s50, 8192
s_mov_b32 s52, 0
buffer_load_dwordx4 v18, s[16:19], s52 offen lds
s_barrier
s_add_u32 m0, s49, 32768
s_add_u32 s52, s45, 640
buffer_load_dwordx4 v16, s[8:11], s52 offen lds
s_add_u32 m0, s49, 33792
s_add_u32 s52, s46, 640
buffer_load_dwordx4 v17, s[8:11], s52 offen lds
s_add_u32 m0, s49, 34816
s_add_u32 s52, s47, 640
buffer_load_dwordx4 v16, s[8:11], s52 offen lds
s_add_u32 m0, s49, 35840
s_add_u32 s52, s48, 640
buffer_load_dwordx4 v17, s[8:11], s52 offen lds
s_add_u32 m0, s50, 16384
s_mov_b32 s52, 1105920
buffer_load_dwordx4 v18, s[12:15], s52 offen lds
s_add_u32 m0, s50, 24576
s_mov_b32 s52, 1105920
buffer_load_dwordx4 v18, s[16:19], s52 offen lds
s_lshl_b32 s53, s41, 8
s_lshl_b32 s54, s42, 3
s_add_u32 s53, s53, s54
s_add_u32 s53, s53, s40
s_mul_i32 s54, s53, 1280
s_lshl_b32 s77, s53, 3
v_lshlrev_b32 v2, 4, v1
v_lshlrev_b32 v3, 2, v1
buffer_load_dwordx4 v[116:119], v2, s[8:11], s54 offen
buffer_load_dword v120, v3, s[8:11], s54 offen offset:1024
v_lshrrev_b32 v4, 5, v1
v_mul_u32_u24 v4, 3456, v4
v_and_b32 v5, 31, v1
v_lshl_add_u32 v4, v5, 2, v4
s_mul_i32 s54, s41, 80
s_mul_i32 s55, s40, 10
s_add_u32 s54, s54, s55
s_mul_i32 s54, s54, 3456
s_lshl_b32 s55, s42, 7
s_add_u32 s54, s54, s55
buffer_load_dword v92, v4, s[12:15], s54 offen
buffer_load_dword v97, v4, s[16:19], s54 offen
s_add_u32 s54, s54, 6912
buffer_load_dword v93, v4, s[12:15], s54 offen
buffer_load_dword v98, v4, s[16:19], s54 offen
s_add_u32 s54, s54, 6912
buffer_load_dword v94, v4, s[12:15], s54 offen
buffer_load_dword v99, v4, s[16:19], s54 offen
s_add_u32 s54, s54, 6912
buffer_load_dword v95, v4, s[12:15], s54 offen
buffer_load_dword v100, v4, s[16:19], s54 offen
s_add_u32 s54, s54, 6912
buffer_load_dword v96, v4, s[12:15], s54 offen
buffer_load_dword v101, v4, s[16:19], s54 offen
v_and_b32 v2, 15, v1
v_lshrrev_b32 v3, 4, v1
v_lshrrev_b32 v4, 1, v2
v_xor_b32 v4, v4, v3
v_lshlrev_b32 v4, 4, v4
s_lshl_b32 s52, s43, 13
v_lshl_add_u32 v4, v2, 7, v4
v_add_u32 v10, s52, v4
v_xor_b32 v11, 64, v10
v_add_u32 v12, 0x10000, v10
v_add_u32 v13, 0x10000, v11
v_lshrrev_b32 v4, 2, v2
v_lshl_add_u32 v4, v3, 3, v4
v_bfe_u32 v5, v1, 3, 1
v_and_b32 v6, 1, v3
v_lshl_or_b32 v5, v6, 1, v5
s_lshl_b32 s52, s44, 1
v_xor_b32 v5, s52, v5
v_lshlrev_b32 v5, 5, v5
v_lshl_add_u32 v4, v4, 7, v5
v_and_b32 v6, 3, v2
v_lshl_add_u32 v4, v6, 3, v4
v_add_u32 v14, 98304, v4
v_xor_b32 v15, 32, v14
s_cmp_eq_u32 s40, 0
s_cselect_b32 s68, 0, 0x40000000
s_waitcnt vmcnt(18)
s_barrier
ds_read_b128 v[20:23], v10 offset:0
ds_read_b64_tr_b16 v[36:37], v14 offset:0
ds_read_b64_tr_b16 v[38:39], v14 offset:512
ds_read_b128 v[24:27], v10 offset:2048
ds_read_b64_tr_b16 v[40:41], v15 offset:0
ds_read_b64_tr_b16 v[42:43], v15 offset:512
ds_read_b128 v[28:31], v10 offset:4096
ds_read_b64_tr_b16 v[44:45], v14 offset:8192
ds_read_b64_tr_b16 v[46:47], v14 offset:8704
ds_read_b128 v[32:35], v10 offset:6144
ds_read_b64_tr_b16 v[48:49], v15 offset:8192
ds_read_b64_tr_b16 v[50:51], v15 offset:8704
s_waitcnt lgkmcnt(0)
v_mfma_f32_16x16x32_bf16 v[128:131], v[36:39], v[20:23], 0
ds_read_b128 v[52:55], v11 offset:0
s_add_u32 m0, s49, 65536
s_add_u32 s52, s45, 128
buffer_load_dwordx4 v16, s[8:11], s52 offen lds
s_lshl_b32 s54, s2, 7
s_add_u32 s53, s68, s54
s_add_u32 s53, s53, 262144
v_mov_b32 v126, 0
v_lshlrev_b32 v127, 15, v1
s_mov_b64 exec, 3
buffer_store_dword v126, v127, s[20:23], s53 offen sc1
s_mov_b64 exec, -1
v_mfma_f32_16x16x32_bf16 v[132:135], v[40:43], v[20:23], 0
ds_read_b64_tr_b16 v[68:69], v14 offset:4096
s_cmp_lt_u32 s2, 4
s_cselect_b32 s53, 0, 0x40000000
v_mfma_f32_16x16x32_bf16 v[136:139], v[36:39], v[24:27], 0
ds_read_b64_tr_b16 v[70:71], v14 offset:4608
s_add_u32 m0, s49, 66560
s_add_u32 s52, s46, 128
buffer_load_dwordx4 v17, s[8:11], s52 offen lds
s_or_b32 s53, s53, s68
v_mfma_f32_16x16x32_bf16 v[140:143], v[40:43], v[24:27], 0
ds_read_b128 v[56:59], v11 offset:2048
v_mfma_f32_16x16x32_bf16 v[160:163], v[44:47], v[20:23], 0
ds_read_b64_tr_b16 v[72:73], v15 offset:4096
s_lshl_b32 s54, s2, 10
v_mfma_f32_16x16x32_bf16 v[144:147], v[36:39], v[28:31], 0
ds_read_b64_tr_b16 v[74:75], v15 offset:4608
s_add_u32 m0, s49, 67584
s_add_u32 s52, s47, 128
buffer_load_dwordx4 v16, s[8:11], s52 offen lds
s_add_u32 s53, s53, s54
v_mfma_f32_16x16x32_bf16 v[168:171], v[44:47], v[24:27], 0
ds_read_b128 v[60:63], v11 offset:4096
s_add_u32 s53, s53, 19922944
v_mfma_f32_16x16x32_bf16 v[148:151], v[40:43], v[28:31], 0
ds_read_b64_tr_b16 v[76:77], v14 offset:12288
v_mfma_f32_16x16x32_bf16 v[176:179], v[44:47], v[28:31], 0
ds_read_b64_tr_b16 v[78:79], v14 offset:12800
s_add_u32 m0, s49, 68608
s_add_u32 s52, s48, 128
buffer_load_dwordx4 v17, s[8:11], s52 offen lds
v_mov_b32 v124, 0
v_mfma_f32_16x16x32_bf16 v[164:167], v[48:51], v[20:23], 0
ds_read_b128 v[64:67], v11 offset:6144
v_mov_b32 v125, 0
v_mfma_f32_16x16x32_bf16 v[152:155], v[36:39], v[32:35], 0
ds_read_b64_tr_b16 v[80:81], v15 offset:12288
s_add_u32 m0, s50, 32768
s_mov_b32 s52, 221184
buffer_load_dwordx4 v18, s[12:15], s52 offen lds
v_mov_b32 v126, 0
v_mfma_f32_16x16x32_bf16 v[172:175], v[48:51], v[24:27], 0
ds_read_b64_tr_b16 v[82:83], v15 offset:12800
v_mfma_f32_16x16x32_bf16 v[156:159], v[40:43], v[32:35], 0
v_mov_b32 v127, 0
v_mfma_f32_16x16x32_bf16 v[180:183], v[48:51], v[28:31], 0
s_add_u32 m0, s50, 40960
s_mov_b32 s52, 221184
buffer_load_dwordx4 v18, s[16:19], s52 offen lds
v_lshlrev_b32 v121, 4, v1
v_mfma_f32_16x16x32_bf16 v[184:187], v[44:47], v[32:35], 0
buffer_store_dwordx4 v[124:127], v121, s[20:23], s53 offen sc1
v_mfma_f32_16x16x32_bf16 v[188:191], v[48:51], v[32:35], 0
s_waitcnt lgkmcnt(0)
s_waitcnt vmcnt(20)
s_barrier
v_mfma_f32_16x16x32_bf16 v[128:131], v[68:71], v[52:55], v[128:131]
ds_read_b128 v[20:23], v10 offset:32768
s_add_u32 m0, s49, 0
s_add_u32 s52, s45, 768
buffer_load_dwordx4 v16, s[8:11], s52 offen lds
s_waitcnt vmcnt(19)
v_mov_b32 v122, 0
v_mov_b32 v123, 0
v_lshlrev_b32 v2, 16, v116
v_and_b32 v3, 0xffff0000, v116
v_add_f32 v122, v122, v2
v_fmac_f32 v123, v2, v2
v_add_f32 v122, v122, v3
v_mfma_f32_16x16x32_bf16 v[132:135], v[72:75], v[52:55], v[132:135]
ds_read_b64_tr_b16 v[36:37], v14 offset:16384
v_fmac_f32 v123, v3, v3
v_lshlrev_b32 v2, 16, v117
v_and_b32 v3, 0xffff0000, v117
v_add_f32 v122, v122, v2
v_fmac_f32 v123, v2, v2
v_add_f32 v122, v122, v3
v_fmac_f32 v123, v3, v3
v_mfma_f32_16x16x32_bf16 v[136:139], v[68:71], v[56:59], v[136:139]
ds_read_b64_tr_b16 v[38:39], v14 offset:16896
v_lshlrev_b32 v2, 16, v118
v_and_b32 v3, 0xffff0000, v118
v_add_f32 v122, v122, v2
v_fmac_f32 v123, v2, v2
v_add_f32 v122, v122, v3
v_fmac_f32 v123, v3, v3
v_lshlrev_b32 v2, 16, v119
v_mfma_f32_16x16x32_bf16 v[140:143], v[72:75], v[56:59], v[140:143]
ds_read_b128 v[24:27], v10 offset:34816
v_and_b32 v3, 0xffff0000, v119
v_add_f32 v122, v122, v2
v_fmac_f32 v123, v2, v2
v_add_f32 v122, v122, v3
v_fmac_f32 v123, v3, v3
v_lshlrev_b32 v2, 16, v120
v_and_b32 v3, 0xffff0000, v120
v_mfma_f32_16x16x32_bf16 v[160:163], v[76:79], v[52:55], v[160:163]
ds_read_b64_tr_b16 v[40:41], v15 offset:16384
v_add_f32 v122, v122, v2
v_fmac_f32 v123, v2, v2
v_add_f32 v122, v122, v3
v_fmac_f32 v123, v3, v3
s_nop 0
v_add_f32_dpp v122, v122, v122 row_shr:1 row_mask:0xf bank_mask:0xf bound_ctrl:0
v_add_f32_dpp v123, v123, v123 row_shr:1 row_mask:0xf bank_mask:0xf bound_ctrl:0
s_nop 0
v_add_f32_dpp v122, v122, v122 row_shr:2 row_mask:0xf bank_mask:0xf bound_ctrl:0
v_mfma_f32_16x16x32_bf16 v[144:147], v[68:71], v[60:63], v[144:147]
ds_read_b64_tr_b16 v[42:43], v15 offset:16896
s_add_u32 m0, s49, 1024
s_add_u32 s52, s46, 768
buffer_load_dwordx4 v17, s[8:11], s52 offen lds
v_add_f32_dpp v123, v123, v123 row_shr:2 row_mask:0xf bank_mask:0xf bound_ctrl:0
v_add_f32_dpp v122, v122, v122 row_shr:4 row_mask:0xf bank_mask:0xf bound_ctrl:0
s_nop 0
v_add_f32_dpp v123, v123, v123 row_shr:4 row_mask:0xf bank_mask:0xf bound_ctrl:0
v_add_f32_dpp v122, v122, v122 row_shr:8 row_mask:0xf bank_mask:0xf bound_ctrl:0
s_nop 0
v_add_f32_dpp v123, v123, v123 row_shr:8 row_mask:0xf bank_mask:0xf bound_ctrl:0
v_add_f32_dpp v122, v122, v122 row_bcast:15 row_mask:0xa bank_mask:0xf
s_nop 0
v_add_f32_dpp v123, v123, v123 row_bcast:15 row_mask:0xa bank_mask:0xf
v_mfma_f32_16x16x32_bf16 v[168:171], v[76:79], v[56:59], v[168:171]
ds_read_b128 v[28:31], v10 offset:36864
v_add_f32_dpp v122, v122, v122 row_bcast:31 row_mask:0xc bank_mask:0xf
v_add_f32_dpp v123, v123, v123 row_bcast:31 row_mask:0xc bank_mask:0xf
v_mul_f32 v122, 0x3acccccd, v122
v_mul_f32 v123, 0x3acccccd, v123
v_fma_f32 v123, -v122, v122, v123
v_max_f32 v123, 0, v123
v_cvt_pk_bf16_f32 v122, v122, v123
v_mfma_f32_16x16x32_bf16 v[148:151], v[72:75], v[60:63], v[148:151]
ds_read_b64_tr_b16 v[44:45], v14 offset:24576
v_and_b32 v123, 0xffff0000, v122
v_lshlrev_b32 v122, 16, v122
v_add_f32 v123, 0x3727c5ac, v123
v_cvt_pk_bf16_f32 v123, v123, v123
v_lshlrev_b32 v123, 16, v123
v_sqrt_f32 v123, v123
s_nop 0
v_cvt_pk_bf16_f32 v123, v123, v123
v_mfma_f32_16x16x32_bf16 v[176:179], v[76:79], v[60:63], v[176:179]
ds_read_b64_tr_b16 v[46:47], v14 offset:25088
v_lshlrev_b32 v123, 16, v123
v_rcp_f32 v123, v123
s_add_u32 s77, s77, 0
s_lshl_b64 exec, 1, 63
buffer_store_dwordx2 v[122:123], off, s[20:23], s77 sc1
s_mov_b64 exec, -1
s_waitcnt vmcnt(11)
v_mov_b32 v2, 0
v_mov_b32 v3, 0
v_mov_b32 v4, 0
v_mov_b32 v5, 0
v_mfma_f32_16x16x32_bf16 v[164:167], v[80:83], v[52:55], v[164:167]
ds_read_b128 v[32:35], v10 offset:38912
v_lshlrev_b32 v6, 16, v92
v_and_b32 v7, 0xffff0000, v92
v_add_f32 v2, v2, v6
v_add_f32 v3, v3, v7
v_lshlrev_b32 v6, 16, v97
v_and_b32 v7, 0xffff0000, v97
v_add_f32 v4, v4, v6
v_mfma_f32_16x16x32_bf16 v[152:155], v[68:71], v[64:67], v[152:155]
ds_read_b64_tr_b16 v[48:49], v15 offset:24576
s_add_u32 m0, s49, 2048
s_add_u32 s52, s47, 768
buffer_load_dwordx4 v16, s[8:11], s52 offen lds
v_add_f32 v5, v5, v7
v_lshlrev_b32 v6, 16, v93
v_and_b32 v7, 0xffff0000, v93
v_add_f32 v2, v2, v6
v_add_f32 v3, v3, v7
v_lshlrev_b32 v6, 16, v98
v_and_b32 v7, 0xffff0000, v98
v_mfma_f32_16x16x32_bf16 v[172:175], v[80:83], v[56:59], v[172:175]
ds_read_b64_tr_b16 v[50:51], v15 offset:25088
v_add_f32 v4, v4, v6
v_add_f32 v5, v5, v7
v_lshlrev_b32 v6, 16, v94
v_and_b32 v7, 0xffff0000, v94
v_add_f32 v2, v2, v6
v_add_f32 v3, v3, v7
v_lshlrev_b32 v6, 16, v99
v_mfma_f32_16x16x32_bf16 v[156:159], v[72:75], v[64:67], v[156:159]
v_and_b32 v7, 0xffff0000, v99
v_add_f32 v4, v4, v6
v_add_f32 v5, v5, v7
v_lshlrev_b32 v6, 16, v95
v_and_b32 v7, 0xffff0000, v95
v_add_f32 v2, v2, v6
v_add_f32 v3, v3, v7
v_mfma_f32_16x16x32_bf16 v[180:183], v[80:83], v[60:63], v[180:183]
v_lshlrev_b32 v6, 16, v100
v_and_b32 v7, 0xffff0000, v100
v_add_f32 v4, v4, v6
v_add_f32 v5, v5, v7
v_lshlrev_b32 v6, 16, v96
v_and_b32 v7, 0xffff0000, v96
v_add_f32 v2, v2, v6
v_mfma_f32_16x16x32_bf16 v[184:187], v[76:79], v[64:67], v[184:187]
v_add_f32 v3, v3, v7
v_lshlrev_b32 v6, 16, v101
v_and_b32 v7, 0xffff0000, v101
v_add_f32 v4, v4, v6
v_add_f32 v5, v5, v7
s_nop 0
v_permlane32_swap_b32 v2, v4
v_permlane32_swap_b32 v3, v5
v_mfma_f32_16x16x32_bf16 v[188:191], v[80:83], v[64:67], v[188:191]
v_add_f32 v2, v2, v4
v_add_f32 v3, v3, v5
s_lshl_b32 s53, s40, 9
s_add_u32 s53, s53, 151552
v_lshlrev_b32 v6, 3, v1
v_add_u32 v6, s53, v6
ds_write_b64 v6, v[2:3]
s_waitcnt lgkmcnt(1)
v_mfma_f32_16x16x32_bf16 v[128:131], v[36:39], v[20:23], v[128:131]
ds_read_b128 v[52:55], v11 offset:32768
s_add_u32 m0, s49, 3072
s_add_u32 s52, s48, 768
buffer_load_dwordx4 v17, s[8:11], s52 offen lds
v_mov_b32 v104, 0
v_mov_b32 v105, 0
v_mfma_f32_16x16x32_bf16 v[132:135], v[40:43], v[20:23], v[132:135]
ds_read_b64_tr_b16 v[68:69], v14 offset:20480
v_mov_b32 v106, 0
v_mfma_f32_16x16x32_bf16 v[136:139], v[36:39], v[24:27], v[136:139]
ds_read_b64_tr_b16 v[70:71], v14 offset:20992
s_lshl_b32 s69, s42, 3
v_mfma_f32_16x16x32_bf16 v[140:143], v[40:43], v[24:27], v[140:143]
ds_read_b128 v[56:59], v11 offset:34816
s_add_u32 s69, s69, s41
v_mfma_f32_16x16x32_bf16 v[160:163], v[44:47], v[20:23], v[160:163]
ds_read_b64_tr_b16 v[72:73], v15 offset:20480
s_lshl_b32 s76, s69, 2
s_and_b32 s60, s40, 3
v_mfma_f32_16x16x32_bf16 v[144:147], v[36:39], v[28:31], v[144:147]
ds_read_b64_tr_b16 v[74:75], v15 offset:20992
s_add_u32 m0, s50, 0
s_mov_b32 s52, 1327104
buffer_load_dwordx4 v18, s[12:15], s52 offen lds
s_add_u32 s76, s76, s60
v_mfma_f32_16x16x32_bf16 v[168:171], v[44:47], v[24:27], v[168:171]
ds_read_b128 v[60:63], v11 offset:36864
s_lshl_b32 s61, s69, 1
v_mfma_f32_16x16x32_bf16 v[148:151], v[40:43], v[28:31], v[148:151]
ds_read_b64_tr_b16 v[76:77], v14 offset:28672
s_add_u32 s61, s61, s40
v_mfma_f32_16x16x32_bf16 v[176:179], v[44:47], v[28:31], v[176:179]
ds_read_b64_tr_b16 v[78:79], v14 offset:29184
s_sub_u32 s61, s61, 6
s_mul_i32 s62, s69, 3
v_mfma_f32_16x16x32_bf16 v[164:167], v[48:51], v[20:23], v[164:167]
ds_read_b128 v[64:67], v11 offset:38912
s_add_u32 s62, s62, s40
v_mfma_f32_16x16x32_bf16 v[152:155], v[36:39], v[32:35], v[152:155]
ds_read_b64_tr_b16 v[80:81], v15 offset:28672
s_add_u32 m0, s50, 8192
s_mov_b32 s52, 1327104
buffer_load_dwordx4 v18, s[16:19], s52 offen lds
s_sub_u32 s62, s62, 2
v_mfma_f32_16x16x32_bf16 v[172:175], v[48:51], v[24:27], v[172:175]
ds_read_b64_tr_b16 v[82:83], v15 offset:29184
s_cmp_lt_u32 s61, 320
s_cselect_b32 s66, 1, 0
v_mfma_f32_16x16x32_bf16 v[156:159], v[40:43], v[32:35], v[156:159]
s_cmp_ge_u32 s40, 6
s_cselect_b32 s66, s66, 0
s_cmp_lt_u32 s62, 540
s_cselect_b32 s60, 2, 0
v_mfma_f32_16x16x32_bf16 v[180:183], v[48:51], v[28:31], v[180:183]
s_sub_u32 s63, s40, 2
v_mfma_f32_16x16x32_bf16 v[184:187], v[44:47], v[32:35], v[184:187]
s_cmp_lt_u32 s63, 3
s_cselect_b32 s66, s60, s66
v_mfma_f32_16x16x32_bf16 v[188:191], v[48:51], v[32:35], v[188:191]
s_cmp_eq_u32 s66, 1
s_cbranch_scc0 SIDE_S2
s_mul_hi_u32 s60, s61, 858993460
s_mul_i32 s63, s60, 5
s_sub_u32 s61, s61, s63
s_lshr_b32 s63, s60, 2
s_lshl_b32 s63, s63, 7
s_and_b32 s64, s60, 3
s_lshl_b32 s64, s64, 3
s_add_u32 s64, s64, s63
s_lshl_b32 s61, s61, 6
s_add_u32 s61, s61, 1
s_mul_i32 s64, s64, 642
s_lshl_b32 s63, s61, 1
s_add_u32 s64, s64, s63
s_lshl_b32 s65, s61, 13
s_lshr_b32 s63, s60, 3
s_lshl_b32 s63, s63, 10
s_add_u32 s65, s65, s63
s_and_b32 s63, s60, 7
s_lshl_b32 s63, s63, 7
s_add_u32 s65, s65, s63
s_add_u32 s65, s65, 12582912
SIDE_S2:
s_cmp_eq_u32 s66, 2
s_cbranch_scc0 SIDE_S3
s_mul_hi_u32 s60, s62, 429496730
s_mul_i32 s63, s60, 10
s_sub_u32 s62, s62, s63
s_mul_i32 s64, s60, 40960
s_lshl_b32 s63, s62, 7
s_add_u32 s64, s64, s63
s_mul_i32 s65, s62, 296
s_add_u32 s65, s65, s60
s_lshl_b32 s65, s65, 10
s_add_u32 s65, s65, 15728640
SIDE_S3:
s_waitcnt lgkmcnt(0)
s_waitcnt vmcnt(8)
s_barrier
v_mfma_f32_16x16x32_bf16 v[128:131], v[68:71], v[52:55], v[128:131]
ds_read_b128 v[20:23], v12 offset:0
s_add_u32 m0, s49, 32768
s_add_u32 s52, s45, 256
buffer_load_dwordx4 v16, s[8:11], s52 offen lds
v_and_b32 v84, 15, v1
v_lshrrev_b32 v85, 4, v1
v_mfma_f32_16x16x32_bf16 v[132:135], v[72:75], v[52:55], v[132:135]
ds_read_b64_tr_b16 v[36:37], v14 offset:32768
s_lshl_b32 s53, s40, 6
v_mfma_f32_16x16x32_bf16 v[136:139], v[68:71], v[56:59], v[136:139]
ds_read_b64_tr_b16 v[38:39], v14 offset:33280
v_lshlrev_b32 v86, 9, v85
v_lshl_add_u32 v86, v84, 2, v86
v_mfma_f32_16x16x32_bf16 v[140:143], v[72:75], v[56:59], v[140:143]
ds_read_b128 v[24:27], v12 offset:2048
s_add_u32 s54, s53, 151552
v_mfma_f32_16x16x32_bf16 v[160:163], v[76:79], v[52:55], v[160:163]
ds_read_b64_tr_b16 v[40:41], v15 offset:32768
v_add_u32 v86, s54, v86
ds_read_b32 v87, v86
v_mfma_f32_16x16x32_bf16 v[144:147], v[68:71], v[60:63], v[144:147]
ds_read_b64_tr_b16 v[42:43], v15 offset:33280
s_add_u32 m0, s49, 33792
s_add_u32 s52, s46, 256
buffer_load_dwordx4 v17, s[8:11], s52 offen lds
ds_read_b32 v88, v86 offset:2048
v_mfma_f32_16x16x32_bf16 v[168:171], v[76:79], v[56:59], v[168:171]
ds_read_b128 v[28:31], v12 offset:4096
s_lshl_b32 s54, s42, 12
s_lshl_b32 s55, s41, 9
v_mfma_f32_16x16x32_bf16 v[148:151], v[72:75], v[60:63], v[148:151]
ds_read_b64_tr_b16 v[44:45], v14 offset:40960
s_add_u32 s54, s54, s55
v_mfma_f32_16x16x32_bf16 v[176:179], v[76:79], v[60:63], v[176:179]
ds_read_b64_tr_b16 v[46:47], v14 offset:41472
s_add_u32 s54, s54, s53
s_add_u32 s80, s54, 65536
v_mfma_f32_16x16x32_bf16 v[164:167], v[80:83], v[52:55], v[164:167]
ds_read_b128 v[32:35], v12 offset:6144
v_lshlrev_b32 v89, 2, v84
v_mfma_f32_16x16x32_bf16 v[152:155], v[68:71], v[64:67], v[152:155]
ds_read_b64_tr_b16 v[48:49], v15 offset:40960
s_add_u32 m0, s49, 34816
s_add_u32 s52, s47, 256
buffer_load_dwordx4 v16, s[8:11], s52 offen lds
s_waitcnt lgkmcnt(5)
v_add_f32 v87, v87, v88
v_mov_b32 v88, v87
v_mfma_f32_16x16x32_bf16 v[172:175], v[80:83], v[56:59], v[172:175]
ds_read_b64_tr_b16 v[50:51], v15 offset:41472
v_permlane16_swap_b32 v88, v87
v_mfma_f32_16x16x32_bf16 v[156:159], v[72:75], v[64:67], v[156:159]
v_add_f32 v87, v87, v88
v_mov_b32 v88, v87
v_mfma_f32_16x16x32_bf16 v[180:183], v[80:83], v[60:63], v[180:183]
s_nop 0
v_permlane32_swap_b32 v88, v87
v_mfma_f32_16x16x32_bf16 v[184:187], v[76:79], v[64:67], v[184:187]
v_add_f32 v87, v87, v88
s_mov_b64 exec, 0xffff
buffer_store_dword v87, v89, s[20:23], s80 offen sc1
s_mov_b64 exec, -1
v_mfma_f32_16x16x32_bf16 v[188:191], v[80:83], v[64:67], v[188:191]
s_cmp_eq_u32 s66, 1
s_cbranch_scc0 SIDE_La6
s_cmp_eq_u32 s40, 6
s_cbranch_scc0 SIDE_La6
v_lshrrev_b32 v104, 3, v1
v_mul_u32_u24 v104, 642, v104
v_and_b32 v105, 7, v1
v_lshl_add_u32 v104, v105, 4, v104
s_add_u32 s60, s64, 0
buffer_load_dwordx4 v[224:227], v104, s[28:31], s60 offen
buffer_load_dwordx4 v[228:231], v104, s[32:35], s60 offen
s_add_u32 s60, s64, 20544
buffer_load_dwordx4 v[232:235], v104, s[28:31], s60 offen
buffer_load_dwordx4 v[236:239], v104, s[32:35], s60 offen
s_add_u32 s60, s64, 41088
buffer_load_dwordx4 v[240:243], v104, s[28:31], s60 offen
buffer_load_dwordx4 v[244:247], v104, s[32:35], s60 offen
s_add_u32 s60, s64, 61632
buffer_load_dwordx4 v[248:251], v104, s[28:31], s60 offen
buffer_load_dwordx4 v[252:255], v104, s[32:35], s60 offen
SIDE_La6:
s_waitcnt lgkmcnt(0)
v_mfma_f32_16x16x32_bf16 v[128:131], v[36:39], v[20:23], v[128:131]
ds_read_b128 v[52:55], v13 offset:0
s_add_u32 m0, s49, 35840
s_add_u32 s52, s48, 256
buffer_load_dwordx4 v17, s[8:11], s52 offen lds
s_cmp_eq_u32 s66, 1
s_cbranch_scc0 SIDE_La7
s_cmp_eq_u32 s40, 7
s_cbranch_scc0 SIDE_La7
v_lshrrev_b32 v104, 3, v1
v_mul_u32_u24 v104, 642, v104
v_and_b32 v105, 7, v1
v_lshl_add_u32 v104, v105, 4, v104
s_add_u32 s60, s64, 0
buffer_load_dwordx4 v[224:227], v104, s[28:31], s60 offen
buffer_load_dwordx4 v[228:231], v104, s[32:35], s60 offen
s_add_u32 s60, s64, 20544
buffer_load_dwordx4 v[232:235], v104, s[28:31], s60 offen
buffer_load_dwordx4 v[236:239], v104, s[32:35], s60 offen
s_add_u32 s60, s64, 41088
buffer_load_dwordx4 v[240:243], v104, s[28:31], s60 offen
buffer_load_dwordx4 v[244:247], v104, s[32:35], s60 offen
s_add_u32 s60, s64, 61632
buffer_load_dwordx4 v[248:251], v104, s[28:31], s60 offen
buffer_load_dwordx4 v[252:255], v104, s[32:35], s60 offen
SIDE_La7:
v_mfma_f32_16x16x32_bf16 v[132:135], v[40:43], v[20:23], v[132:135]
ds_read_b64_tr_b16 v[68:69], v14 offset:36864
v_mfma_f32_16x16x32_bf16 v[136:139], v[36:39], v[24:27], v[136:139]
ds_read_b64_tr_b16 v[70:71], v14 offset:37376
v_mfma_f32_16x16x32_bf16 v[140:143], v[40:43], v[24:27], v[140:143]
ds_read_b128 v[56:59], v13 offset:2048
v_mfma_f32_16x16x32_bf16 v[160:163], v[44:47], v[20:23], v[160:163]
ds_read_b64_tr_b16 v[72:73], v15 offset:36864
v_mfma_f32_16x16x32_bf16 v[144:147], v[36:39], v[28:31], v[144:147]
ds_read_b64_tr_b16 v[74:75], v15 offset:37376
s_add_u32 m0, s50, 16384
s_mov_b32 s52, 442368
buffer_load_dwordx4 v18, s[12:15], s52 offen lds
v_mfma_f32_16x16x32_bf16 v[168:171], v[44:47], v[24:27], v[168:171]
ds_read_b128 v[60:63], v13 offset:4096
v_mfma_f32_16x16x32_bf16 v[148:151], v[40:43], v[28:31], v[148:151]
ds_read_b64_tr_b16 v[76:77], v14 offset:45056
v_mfma_f32_16x16x32_bf16 v[176:179], v[44:47], v[28:31], v[176:179]
ds_read_b64_tr_b16 v[78:79], v14 offset:45568
v_mfma_f32_16x16x32_bf16 v[164:167], v[48:51], v[20:23], v[164:167]
ds_read_b128 v[64:67], v13 offset:6144
v_mfma_f32_16x16x32_bf16 v[152:155], v[36:39], v[32:35], v[152:155]
ds_read_b64_tr_b16 v[80:81], v15 offset:45056
s_add_u32 m0, s50, 24576
s_mov_b32 s52, 442368
buffer_load_dwordx4 v18, s[16:19], s52 offen lds
v_mfma_f32_16x16x32_bf16 v[172:175], v[48:51], v[24:27], v[172:175]
ds_read_b64_tr_b16 v[82:83], v15 offset:45568
v_mfma_f32_16x16x32_bf16 v[156:159], v[40:43], v[32:35], v[156:159]
v_mfma_f32_16x16x32_bf16 v[180:183], v[48:51], v[28:31], v[180:183]
v_mfma_f32_16x16x32_bf16 v[184:187], v[44:47], v[32:35], v[184:187]
v_mfma_f32_16x16x32_bf16 v[188:191], v[48:51], v[32:35], v[188:191]
s_waitcnt lgkmcnt(0)
s_waitcnt vmcnt(7)
s_barrier
v_mfma_f32_16x16x32_bf16 v[128:131], v[68:71], v[52:55], v[128:131]
ds_read_b128 v[20:23], v10 offset:0
s_add_u32 m0, s49, 65536
s_add_u32 s52, s45, 896
buffer_load_dwordx4 v16, s[8:11], s52 offen lds
s_cmp_eq_u32 s66, 2
s_cbranch_scc0 SIDE_Lb
v_bfe_u32 v104, v1, 4, 1
v_lshlrev_b32 v104, 1, v104
v_and_b32 v105, 7, v1
v_xor_b32 v104, v104, v105
v_lshlrev_b32 v104, 4, v104
v_lshrrev_b32 v105, 3, v1
v_mul_u32_u24 v105, 1280, v105
v_add_u32 v104, v104, v105
v_xor_b32 v105, 64, v104
s_sub_u32 s61, s40, 2
s_lshl_b32 s61, s61, 12
s_add_u32 s61, s61, 151552
s_add_u32 m0, s61, 0
s_add_u32 s60, s64, 0
buffer_load_dwordx4 v104, s[24:27], s60 offen lds
s_add_u32 m0, s61, 1024
s_add_u32 s60, s64, 10240
buffer_load_dwordx4 v105, s[24:27], s60 offen lds
s_add_u32 m0, s61, 2048
s_add_u32 s60, s64, 20480
buffer_load_dwordx4 v104, s[24:27], s60 offen lds
s_add_u32 m0, s61, 3072
s_add_u32 s60, s64, 30720
buffer_load_dwordx4 v105, s[24:27], s60 offen lds
SIDE_Lb:
v_mfma_f32_16x16x32_bf16 v[132:135], v[72:75], v[52:55], v[132:135]
ds_read_b64_tr_b16 v[36:37], v14 offset:0
v_mfma_f32_16x16x32_bf16 v[136:139], v[68:71], v[56:59], v[136:139]
ds_read_b64_tr_b16 v[38:39], v14 offset:512
v_mfma_f32_16x16x32_bf16 v[140:143], v[72:75], v[56:59], v[140:143]
ds_read_b128 v[24:27], v10 offset:2048
v_mfma_f32_16x16x32_bf16 v[160:163], v[76:79], v[52:55], v[160:163]
ds_read_b64_tr_b16 v[40:41], v15 offset:0
v_mfma_f32_16x16x32_bf16 v[144:147], v[68:71], v[60:63], v[144:147]
ds_read_b64_tr_b16 v[42:43], v15 offset:512
s_add_u32 m0, s49, 66560
s_add_u32 s52, s46, 896
buffer_load_dwordx4 v17, s[8:11], s52 offen lds
v_mfma_f32_16x16x32_bf16 v[168:171], v[76:79], v[56:59], v[168:171]
ds_read_b128 v[28:31], v10 offset:4096
v_mfma_f32_16x16x32_bf16 v[148:151], v[72:75], v[60:63], v[148:151]
ds_read_b64_tr_b16 v[44:45], v14 offset:8192
v_mfma_f32_16x16x32_bf16 v[176:179], v[76:79], v[60:63], v[176:179]
ds_read_b64_tr_b16 v[46:47], v14 offset:8704
v_mfma_f32_16x16x32_bf16 v[164:167], v[80:83], v[52:55], v[164:167]
ds_read_b128 v[32:35], v10 offset:6144
v_mfma_f32_16x16x32_bf16 v[152:155], v[68:71], v[64:67], v[152:155]
ds_read_b64_tr_b16 v[48:49], v15 offset:8192
s_add_u32 m0, s49, 67584
s_add_u32 s52, s47, 896
buffer_load_dwordx4 v16, s[8:11], s52 offen lds
v_mfma_f32_16x16x32_bf16 v[172:175], v[80:83], v[56:59], v[172:175]
ds_read_b64_tr_b16 v[50:51], v15 offset:8704
v_mfma_f32_16x16x32_bf16 v[156:159], v[72:75], v[64:67], v[156:159]
v_mfma_f32_16x16x32_bf16 v[180:183], v[80:83], v[60:63], v[180:183]
v_mfma_f32_16x16x32_bf16 v[184:187], v[76:79], v[64:67], v[184:187]
v_mfma_f32_16x16x32_bf16 v[188:191], v[80:83], v[64:67], v[188:191]
s_waitcnt lgkmcnt(0)
v_mfma_f32_16x16x32_bf16 v[128:131], v[36:39], v[20:23], v[128:131]
ds_read_b128 v[52:55], v11 offset:0
s_add_u32 m0, s49, 68608
s_add_u32 s52, s48, 896
buffer_load_dwordx4 v17, s[8:11], s52 offen lds
s_cmp_ge_u32 s40, 4
s_cselect_b32 s67, s76, 0x7fffffff
s_mul_hi_u32 s60, s76, 214748365
s_mul_i32 s61, s60, 20
v_mfma_f32_16x16x32_bf16 v[132:135], v[40:43], v[20:23], v[132:135]
ds_read_b64_tr_b16 v[68:69], v14 offset:4096
s_sub_u32 s61, s76, s61
s_mul_i32 s62, s60, 74
v_mfma_f32_16x16x32_bf16 v[136:139], v[36:39], v[24:27], v[136:139]
ds_read_b64_tr_b16 v[70:71], v14 offset:4608
s_add_u32 s62, s62, s61
s_add_u32 s62, s62, 54
v_mfma_f32_16x16x32_bf16 v[140:143], v[40:43], v[24:27], v[140:143]
ds_read_b128 v[56:59], v11 offset:2048
s_lshl_b32 s62, s62, 10
s_add_u32 s62, s62, 15728640
v_mfma_f32_16x16x32_bf16 v[160:163], v[44:47], v[20:23], v[160:163]
ds_read_b64_tr_b16 v[72:73], v15 offset:4096
s_cmp_lt_u32 s67, 800
s_cselect_b32 s67, s62, 1073741824
s_lshl_b32 s60, s60, 4
v_mfma_f32_16x16x32_bf16 v[144:147], v[36:39], v[28:31], v[144:147]
ds_read_b64_tr_b16 v[74:75], v15 offset:4608
s_add_u32 m0, s50, 32768
s_mov_b32 s52, 1548288
buffer_load_dwordx4 v18, s[12:15], s52 offen lds
s_lshl_b32 s61, s61, 4
v_and_b32 v107, 15, v1
v_add_u32 v107, s60, v107
v_mfma_f32_16x16x32_bf16 v[168:171], v[44:47], v[24:27], v[168:171]
ds_read_b128 v[60:63], v11 offset:4096
v_cvt_f32_u32 v108, v107
v_lshrrev_b32 v109, 4, v1
v_mfma_f32_16x16x32_bf16 v[148:151], v[40:43], v[28:31], v[148:151]
ds_read_b64_tr_b16 v[76:77], v14 offset:12288
v_lshl_add_u32 v109, v109, 2, s61
s_mov_b32 s63, 0xc4200000
v_mfma_f32_16x16x32_bf16 v[176:179], v[44:47], v[28:31], v[176:179]
ds_read_b64_tr_b16 v[78:79], v14 offset:12800
v_add_u32 v110, 0, v109
v_cvt_f32_u32 v110, v110
v_mfma_f32_16x16x32_bf16 v[164:167], v[48:51], v[20:23], v[164:167]
ds_read_b128 v[64:67], v11 offset:6144
v_mul_f32 v110, v110, v108
v_mul_f32 v111, 0x3acccccd, v110
v_mfma_f32_16x16x32_bf16 v[152:155], v[36:39], v[32:35], v[152:155]
ds_read_b64_tr_b16 v[80:81], v15 offset:12288
s_add_u32 m0, s50, 40960
s_mov_b32 s52, 1548288
buffer_load_dwordx4 v18, s[16:19], s52 offen lds
v_floor_f32 v111, v111
v_fma_f32 v111, v111, s63, v110
v_mul_f32 v111, 0x3acccccd, v111
v_mfma_f32_16x16x32_bf16 v[172:175], v[48:51], v[24:27], v[172:175]
ds_read_b64_tr_b16 v[82:83], v15 offset:12800
v_cos_f32 v112, v111
v_sin_f32 v113, v111
v_mfma_f32_16x16x32_bf16 v[156:159], v[40:43], v[32:35], v[156:159]
v_add_f32 v112, v112, v112
v_mul_f32 v113, -2.0, v113
v_mfma_f32_16x16x32_bf16 v[180:183], v[48:51], v[28:31], v[180:183]
v_cvt_pk_bf16_f32 v92, v112, v113
v_add_u32 v110, 1, v109
v_mfma_f32_16x16x32_bf16 v[184:187], v[44:47], v[32:35], v[184:187]
v_cvt_f32_u32 v110, v110
v_mul_f32 v110, v110, v108
v_mfma_f32_16x16x32_bf16 v[188:191], v[48:51], v[32:35], v[188:191]
v_mul_f32 v111, 0x3acccccd, v110
v_floor_f32 v111, v111
s_waitcnt lgkmcnt(0)
s_waitcnt vmcnt(6)
s_barrier
v_mfma_f32_16x16x32_bf16 v[128:131], v[68:71], v[52:55], v[128:131]
ds_read_b128 v[20:23], v10 offset:32768
s_add_u32 m0, s49, 0
s_add_u32 s52, s45, 384
buffer_load_dwordx4 v16, s[8:11], s52 offen lds
s_and_b32 s53, s2, 7
s_lshl_b32 s53, s53, 5
s_add_u32 s53, s53, s68
v_mov_b32 v126, 1
s_mov_b64 exec, 1
buffer_atomic_add v126, off, s[36:39], s53
s_mov_b64 exec, -1
v_fma_f32 v111, v111, s63, v110
v_mul_f32 v111, 0x3acccccd, v111
v_mfma_f32_16x16x32_bf16 v[132:135], v[72:75], v[52:55], v[132:135]
ds_read_b64_tr_b16 v[36:37], v14 offset:16384
v_cos_f32 v112, v111
v_sin_f32 v113, v111
v_mfma_f32_16x16x32_bf16 v[136:139], v[68:71], v[56:59], v[136:139]
ds_read_b64_tr_b16 v[38:39], v14 offset:16896
v_add_f32 v112, v112, v112
v_mul_f32 v113, -2.0, v113
v_cvt_pk_bf16_f32 v93, v112, v113
v_mfma_f32_16x16x32_bf16 v[140:143], v[72:75], v[56:59], v[140:143]
ds_read_b128 v[24:27], v10 offset:34816
v_add_u32 v110, 2, v109
v_cvt_f32_u32 v110, v110
v_mfma_f32_16x16x32_bf16 v[160:163], v[76:79], v[52:55], v[160:163]
ds_read_b64_tr_b16 v[40:41], v15 offset:16384
v_mul_f32 v110, v110, v108
v_mul_f32 v111, 0x3acccccd, v110
v_mfma_f32_16x16x32_bf16 v[144:147], v[68:71], v[60:63], v[144:147]
ds_read_b64_tr_b16 v[42:43], v15 offset:16896
s_add_u32 m0, s49, 1024
s_add_u32 s52, s46, 384
buffer_load_dwordx4 v17, s[8:11], s52 offen lds
v_floor_f32 v111, v111
v_fma_f32 v111, v111, s63, v110
v_mul_f32 v111, 0x3acccccd, v111
v_mfma_f32_16x16x32_bf16 v[168:171], v[76:79], v[56:59], v[168:171]
ds_read_b128 v[28:31], v10 offset:36864
v_cos_f32 v112, v111
v_sin_f32 v113, v111
v_mfma_f32_16x16x32_bf16 v[148:151], v[72:75], v[60:63], v[148:151]
ds_read_b64_tr_b16 v[44:45], v14 offset:24576
v_add_f32 v112, v112, v112
v_mul_f32 v113, -2.0, v113
v_mfma_f32_16x16x32_bf16 v[176:179], v[76:79], v[60:63], v[176:179]
ds_read_b64_tr_b16 v[46:47], v14 offset:25088
v_cvt_pk_bf16_f32 v94, v112, v113
v_add_u32 v110, 3, v109
v_cvt_f32_u32 v110, v110
v_mfma_f32_16x16x32_bf16 v[164:167], v[80:83], v[52:55], v[164:167]
ds_read_b128 v[32:35], v10 offset:38912
v_mul_f32 v110, v110, v108
v_mul_f32 v111, 0x3acccccd, v110
v_mfma_f32_16x16x32_bf16 v[152:155], v[68:71], v[64:67], v[152:155]
ds_read_b64_tr_b16 v[48:49], v15 offset:24576
s_add_u32 m0, s49, 2048
s_add_u32 s52, s47, 384
buffer_load_dwordx4 v16, s[8:11], s52 offen lds
v_floor_f32 v111, v111
v_fma_f32 v111, v111, s63, v110
v_mul_f32 v111, 0x3acccccd, v111
v_mfma_f32_16x16x32_bf16 v[172:175], v[80:83], v[56:59], v[172:175]
ds_read_b64_tr_b16 v[50:51], v15 offset:25088
v_cos_f32 v112, v111
v_sin_f32 v113, v111
v_mfma_f32_16x16x32_bf16 v[156:159], v[72:75], v[64:67], v[156:159]
v_add_f32 v112, v112, v112
v_mul_f32 v113, -2.0, v113
v_mfma_f32_16x16x32_bf16 v[180:183], v[80:83], v[60:63], v[180:183]
v_cvt_pk_bf16_f32 v95, v112, v113
v_and_b32 v110, 1, v107
v_lshlrev_b32 v110, 31, v110
v_mfma_f32_16x16x32_bf16 v[184:187], v[76:79], v[64:67], v[184:187]
v_or_b32 v110, 0x3f800000, v110
v_cmp_eq_u32 vcc, 0, v109
s_nop 1
v_cndmask_b32 v92, v92, v110, vcc
v_mfma_f32_16x16x32_bf16 v[188:191], v[80:83], v[64:67], v[188:191]
v_lshlrev_b32 v108, 4, v1
buffer_store_dwordx4 v[92:95], v108, s[20:23], s67 offen sc1
s_waitcnt lgkmcnt(0)
v_mfma_f32_16x16x32_bf16 v[128:131], v[36:39], v[20:23], v[128:131]
ds_read_b128 v[52:55], v11 offset:32768
s_add_u32 m0, s49, 3072
s_add_u32 s52, s48, 384
buffer_load_dwordx4 v17, s[8:11], s52 offen lds
s_cmp_eq_u32 s66, 2
s_cbranch_scc0 SIDE_Fa
s_waitcnt vmcnt(11)
s_sub_u32 s61, s40, 2
s_lshl_b32 s61, s61, 12
s_add_u32 s61, s61, 151552
v_and_b32 v104, 15, v1
v_lshrrev_b32 v105, 4, v1
v_lshrrev_b32 v106, 2, v104
v_lshl_add_u32 v106, v105, 2, v106
v_bfe_u32 v105, v106, 1, 1
v_bfe_u32 v192, v106, 3, 1
v_lshl_or_b32 v105, v192, 1, v105
v_lshlrev_b32 v105, 5, v105
v_lshl_add_u32 v106, v106, 7, v105
v_and_b32 v104, 3, v104
v_lshl_add_u32 v106, v104, 3, v106
v_add_u32 v106, s61, v106
v_xor_b32 v104, 0, v106
ds_read_b64_tr_b16 v[192:193], v104
ds_read_b64_tr_b16 v[194:195], v104 offset:2048
v_xor_b32 v104, 32, v106
ds_read_b64_tr_b16 v[196:197], v104
ds_read_b64_tr_b16 v[198:199], v104 offset:2048
v_xor_b32 v104, 64, v106
ds_read_b64_tr_b16 v[200:201], v104
ds_read_b64_tr_b16 v[202:203], v104 offset:2048
v_xor_b32 v104, 96, v106
ds_read_b64_tr_b16 v[204:205], v104
ds_read_b64_tr_b16 v[206:207], v104 offset:2048
SIDE_Fa:
v_mfma_f32_16x16x32_bf16 v[132:135], v[40:43], v[20:23], v[132:135]
ds_read_b64_tr_b16 v[68:69], v14 offset:20480
v_mfma_f32_16x16x32_bf16 v[136:139], v[36:39], v[24:27], v[136:139]
ds_read_b64_tr_b16 v[70:71], v14 offset:20992
v_mfma_f32_16x16x32_bf16 v[140:143], v[40:43], v[24:27], v[140:143]
ds_read_b128 v[56:59], v11 offset:34816
v_mfma_f32_16x16x32_bf16 v[160:163], v[44:47], v[20:23], v[160:163]
ds_read_b64_tr_b16 v[72:73], v15 offset:20480
v_mfma_f32_16x16x32_bf16 v[144:147], v[36:39], v[28:31], v[144:147]
ds_read_b64_tr_b16 v[74:75], v15 offset:20992
s_add_u32 m0, s50, 0
s_mov_b32 s52, 663552
buffer_load_dwordx4 v18, s[12:15], s52 offen lds
v_mfma_f32_16x16x32_bf16 v[168:171], v[44:47], v[24:27], v[168:171]
ds_read_b128 v[60:63], v11 offset:36864
v_mfma_f32_16x16x32_bf16 v[148:151], v[40:43], v[28:31], v[148:151]
ds_read_b64_tr_b16 v[76:77], v14 offset:28672
v_mfma_f32_16x16x32_bf16 v[176:179], v[44:47], v[28:31], v[176:179]
ds_read_b64_tr_b16 v[78:79], v14 offset:29184
v_mfma_f32_16x16x32_bf16 v[164:167], v[48:51], v[20:23], v[164:167]
ds_read_b128 v[64:67], v11 offset:38912
v_mfma_f32_16x16x32_bf16 v[152:155], v[36:39], v[32:35], v[152:155]
ds_read_b64_tr_b16 v[80:81], v15 offset:28672
s_add_u32 m0, s50, 8192
s_mov_b32 s52, 663552
buffer_load_dwordx4 v18, s[16:19], s52 offen lds
v_mfma_f32_16x16x32_bf16 v[172:175], v[48:51], v[24:27], v[172:175]
ds_read_b64_tr_b16 v[82:83], v15 offset:29184
v_mfma_f32_16x16x32_bf16 v[156:159], v[40:43], v[32:35], v[156:159]
v_mfma_f32_16x16x32_bf16 v[180:183], v[48:51], v[28:31], v[180:183]
v_mfma_f32_16x16x32_bf16 v[184:187], v[44:47], v[32:35], v[184:187]
v_mfma_f32_16x16x32_bf16 v[188:191], v[48:51], v[32:35], v[188:191]
s_waitcnt lgkmcnt(0)
s_waitcnt vmcnt(8)
s_barrier
v_mfma_f32_16x16x32_bf16 v[128:131], v[68:71], v[52:55], v[128:131]
ds_read_b128 v[20:23], v12 offset:0
s_add_u32 m0, s49, 32768
s_add_u32 s52, s45, 1024
buffer_load_dwordx4 v16, s[8:11], s52 offen lds
s_cmp_eq_u32 s66, 2
s_cbranch_scc0 SIDE_Fc
s_waitcnt lgkmcnt(0)
v_lshlrev_b32 v105, 4, v1
s_add_u32 s60, s65, 0
buffer_store_dwordx4 v[192:195], v105, s[20:23], s60 offen sc1
s_add_u32 s60, s65, 75776
buffer_store_dwordx4 v[196:199], v105, s[20:23], s60 offen sc1
s_add_u32 s60, s65, 151552
buffer_store_dwordx4 v[200:203], v105, s[20:23], s60 offen sc1
s_add_u32 s60, s65, 227328
buffer_store_dwordx4 v[204:207], v105, s[20:23], s60 offen sc1
SIDE_Fc:
v_mfma_f32_16x16x32_bf16 v[132:135], v[72:75], v[52:55], v[132:135]
ds_read_b64_tr_b16 v[36:37], v14 offset:32768
v_mfma_f32_16x16x32_bf16 v[136:139], v[68:71], v[56:59], v[136:139]
ds_read_b64_tr_b16 v[38:39], v14 offset:33280
v_mfma_f32_16x16x32_bf16 v[140:143], v[72:75], v[56:59], v[140:143]
ds_read_b128 v[24:27], v12 offset:2048
v_mfma_f32_16x16x32_bf16 v[160:163], v[76:79], v[52:55], v[160:163]
ds_read_b64_tr_b16 v[40:41], v15 offset:32768
v_mfma_f32_16x16x32_bf16 v[144:147], v[68:71], v[60:63], v[144:147]
ds_read_b64_tr_b16 v[42:43], v15 offset:33280
s_add_u32 m0, s49, 33792
s_add_u32 s52, s46, 1024
buffer_load_dwordx4 v17, s[8:11], s52 offen lds
v_mfma_f32_16x16x32_bf16 v[168:171], v[76:79], v[56:59], v[168:171]
ds_read_b128 v[28:31], v12 offset:4096
v_mfma_f32_16x16x32_bf16 v[148:151], v[72:75], v[60:63], v[148:151]
ds_read_b64_tr_b16 v[44:45], v14 offset:40960
v_mfma_f32_16x16x32_bf16 v[176:179], v[76:79], v[60:63], v[176:179]
ds_read_b64_tr_b16 v[46:47], v14 offset:41472
s_cmp_eq_u32 s66, 1
s_cbranch_scc0 SIDE_T6a0
s_cmp_eq_u32 s40, 6
s_cbranch_scc0 SIDE_T6a0
s_waitcnt vmcnt(19)
v_lshrrev_b32 v104, 3, v1
v_and_b32 v105, 7, v1
v_xor_b32 v104, v104, v105
v_lshlrev_b32 v104, 4, v104
v_lshl_add_u32 v104, v105, 10, v104
v_add_u32 v104, 151552, v104
s_mov_b32 s60, 0x05040100
s_mov_b32 s62, 0x07060302
v_perm_b32 v208, v228, v224, s60
v_perm_b32 v209, v236, v232, s60
v_perm_b32 v210, v244, v240, s60
v_perm_b32 v211, v252, v248, s60
ds_write_b128 v104, v[208:211] offset:0
v_perm_b32 v212, v228, v224, s62
v_perm_b32 v213, v236, v232, s62
v_perm_b32 v214, v244, v240, s62
v_perm_b32 v215, v252, v248, s62
ds_write_b128 v104, v[212:215] offset:128
v_perm_b32 v216, v229, v225, s60
v_perm_b32 v217, v237, v233, s60
v_perm_b32 v218, v245, v241, s60
v_perm_b32 v219, v253, v249, s60
ds_write_b128 v104, v[216:219] offset:256
v_perm_b32 v220, v229, v225, s62
v_perm_b32 v221, v237, v233, s62
v_perm_b32 v222, v245, v241, s62
v_perm_b32 v223, v253, v249, s62
ds_write_b128 v104, v[220:223] offset:384
SIDE_T6a0:
v_mfma_f32_16x16x32_bf16 v[164:167], v[80:83], v[52:55], v[164:167]
ds_read_b128 v[32:35], v12 offset:6144
v_mfma_f32_16x16x32_bf16 v[152:155], v[68:71], v[64:67], v[152:155]
ds_read_b64_tr_b16 v[48:49], v15 offset:40960
s_add_u32 m0, s49, 34816
s_add_u32 s52, s47, 1024
buffer_load_dwordx4 v16, s[8:11], s52 offen lds
v_mfma_f32_16x16x32_bf16 v[172:175], v[80:83], v[56:59], v[172:175]
ds_read_b64_tr_b16 v[50:51], v15 offset:41472
v_mfma_f32_16x16x32_bf16 v[156:159], v[72:75], v[64:67], v[156:159]
v_mfma_f32_16x16x32_bf16 v[180:183], v[80:83], v[60:63], v[180:183]
v_mfma_f32_16x16x32_bf16 v[184:187], v[76:79], v[64:67], v[184:187]
v_mfma_f32_16x16x32_bf16 v[188:191], v[80:83], v[64:67], v[188:191]
s_waitcnt lgkmcnt(0)
v_mfma_f32_16x16x32_bf16 v[128:131], v[36:39], v[20:23], v[128:131]
ds_read_b128 v[52:55], v13 offset:0
s_add_u32 m0, s49, 35840
s_add_u32 s52, s48, 1024
buffer_load_dwordx4 v17, s[8:11], s52 offen lds
s_cmp_eq_u32 s66, 1
s_cbranch_scc0 SIDE_T6a1
s_cmp_eq_u32 s40, 6
s_cbranch_scc0 SIDE_T6a1
s_mov_b32 s60, 0x05040100
s_mov_b32 s62, 0x07060302
v_perm_b32 v208, v230, v226, s60
v_perm_b32 v209, v238, v234, s60
v_perm_b32 v210, v246, v242, s60
v_perm_b32 v211, v254, v250, s60
ds_write_b128 v104, v[208:211] offset:512
v_perm_b32 v212, v230, v226, s62
v_perm_b32 v213, v238, v234, s62
v_perm_b32 v214, v246, v242, s62
v_perm_b32 v215, v254, v250, s62
ds_write_b128 v104, v[212:215] offset:640
v_perm_b32 v216, v231, v227, s60
v_perm_b32 v217, v239, v235, s60
v_perm_b32 v218, v247, v243, s60
v_perm_b32 v219, v255, v251, s60
ds_write_b128 v104, v[216:219] offset:768
v_perm_b32 v220, v231, v227, s62
v_perm_b32 v221, v239, v235, s62
v_perm_b32 v222, v247, v243, s62
v_perm_b32 v223, v255, v251, s62
ds_write_b128 v104, v[220:223] offset:896
SIDE_T6a1:
v_mfma_f32_16x16x32_bf16 v[132:135], v[40:43], v[20:23], v[132:135]
ds_read_b64_tr_b16 v[68:69], v14 offset:36864
v_mfma_f32_16x16x32_bf16 v[136:139], v[36:39], v[24:27], v[136:139]
ds_read_b64_tr_b16 v[70:71], v14 offset:37376
v_mfma_f32_16x16x32_bf16 v[140:143], v[40:43], v[24:27], v[140:143]
ds_read_b128 v[56:59], v13 offset:2048
v_mfma_f32_16x16x32_bf16 v[160:163], v[44:47], v[20:23], v[160:163]
ds_read_b64_tr_b16 v[72:73], v15 offset:36864
v_mfma_f32_16x16x32_bf16 v[144:147], v[36:39], v[28:31], v[144:147]
ds_read_b64_tr_b16 v[74:75], v15 offset:37376
s_add_u32 m0, s50, 16384
s_mov_b32 s52, 1769472
buffer_load_dwordx4 v18, s[12:15], s52 offen lds
v_mfma_f32_16x16x32_bf16 v[168:171], v[44:47], v[24:27], v[168:171]
ds_read_b128 v[60:63], v13 offset:4096
v_mfma_f32_16x16x32_bf16 v[148:151], v[40:43], v[28:31], v[148:151]
ds_read_b64_tr_b16 v[76:77], v14 offset:45056
v_mfma_f32_16x16x32_bf16 v[176:179], v[44:47], v[28:31], v[176:179]
ds_read_b64_tr_b16 v[78:79], v14 offset:45568
s_cmp_eq_u32 s66, 1
s_cbranch_scc0 SIDE_T6b
s_cmp_eq_u32 s40, 6
s_cbranch_scc0 SIDE_T6b
v_lshrrev_b32 v105, 3, v1
v_and_b32 v106, 7, v1
v_lshlrev_b32 v104, 7, v105
v_lshl_add_u32 v104, v106, 4, v104
v_add_u32 v104, 151552, v104
v_lshlrev_b32 v105, 13, v105
v_lshl_add_u32 v105, v106, 4, v105
s_waitcnt lgkmcnt(0)
v_xor_b32 v106, 0, v104
ds_read_b128 v[224:227], v106 offset:0
v_xor_b32 v106, 16, v104
ds_read_b128 v[228:231], v106 offset:1024
v_xor_b32 v106, 32, v104
ds_read_b128 v[232:235], v106 offset:2048
v_xor_b32 v106, 48, v104
ds_read_b128 v[236:239], v106 offset:3072
v_xor_b32 v106, 64, v104
ds_read_b128 v[240:243], v106 offset:4096
v_xor_b32 v106, 80, v104
ds_read_b128 v[244:247], v106 offset:5120
v_xor_b32 v106, 96, v104
ds_read_b128 v[248:251], v106 offset:6144
v_xor_b32 v106, 112, v104
ds_read_b128 v[252:255], v106 offset:7168
SIDE_T6b:
v_mfma_f32_16x16x32_bf16 v[164:167], v[48:51], v[20:23], v[164:167]
ds_read_b128 v[64:67], v13 offset:6144
v_mfma_f32_16x16x32_bf16 v[152:155], v[36:39], v[32:35], v[152:155]
ds_read_b64_tr_b16 v[80:81], v15 offset:45056
s_add_u32 m0, s50, 24576
s_mov_b32 s52, 1769472
buffer_load_dwordx4 v18, s[16:19], s52 offen lds
v_mfma_f32_16x16x32_bf16 v[172:175], v[48:51], v[24:27], v[172:175]
ds_read_b64_tr_b16 v[82:83], v15 offset:45568
v_mfma_f32_16x16x32_bf16 v[156:159], v[40:43], v[32:35], v[156:159]
v_mfma_f32_16x16x32_bf16 v[180:183], v[48:51], v[28:31], v[180:183]
v_mfma_f32_16x16x32_bf16 v[184:187], v[44:47], v[32:35], v[184:187]
v_mfma_f32_16x16x32_bf16 v[188:191], v[48:51], v[32:35], v[188:191]
s_waitcnt lgkmcnt(0)
s_waitcnt vmcnt(6)
s_barrier
v_mfma_f32_16x16x32_bf16 v[128:131], v[68:71], v[52:55], v[128:131]
ds_read_b128 v[20:23], v10 offset:0
s_add_u32 m0, s49, 65536
s_add_u32 s52, s45, 512
buffer_load_dwordx4 v16, s[8:11], s52 offen lds
s_cmp_eq_u32 s66, 1
s_cbranch_scc0 SIDE_T6c
s_cmp_eq_u32 s40, 6
s_cbranch_scc0 SIDE_T6c
s_waitcnt lgkmcnt(0)
s_add_u32 s60, s65, 0
buffer_store_dwordx4 v[224:227], v105, s[20:23], s60 offen sc1
s_add_u32 s60, s65, 65536
buffer_store_dwordx4 v[228:231], v105, s[20:23], s60 offen sc1
s_add_u32 s60, s65, 131072
buffer_store_dwordx4 v[232:235], v105, s[20:23], s60 offen sc1
s_add_u32 s60, s65, 196608
buffer_store_dwordx4 v[236:239], v105, s[20:23], s60 offen sc1
s_add_u32 s60, s65, 262144
buffer_store_dwordx4 v[240:243], v105, s[20:23], s60 offen sc1
s_add_u32 s60, s65, 327680
buffer_store_dwordx4 v[244:247], v105, s[20:23], s60 offen sc1
s_add_u32 s60, s65, 393216
buffer_store_dwordx4 v[248:251], v105, s[20:23], s60 offen sc1
s_add_u32 s60, s65, 458752
buffer_store_dwordx4 v[252:255], v105, s[20:23], s60 offen sc1
SIDE_T6c:
v_mfma_f32_16x16x32_bf16 v[132:135], v[72:75], v[52:55], v[132:135]
ds_read_b64_tr_b16 v[36:37], v14 offset:0
v_mfma_f32_16x16x32_bf16 v[136:139], v[68:71], v[56:59], v[136:139]
ds_read_b64_tr_b16 v[38:39], v14 offset:512
v_mfma_f32_16x16x32_bf16 v[140:143], v[72:75], v[56:59], v[140:143]
ds_read_b128 v[24:27], v10 offset:2048
v_mfma_f32_16x16x32_bf16 v[160:163], v[76:79], v[52:55], v[160:163]
ds_read_b64_tr_b16 v[40:41], v15 offset:0
v_mfma_f32_16x16x32_bf16 v[144:147], v[68:71], v[60:63], v[144:147]
ds_read_b64_tr_b16 v[42:43], v15 offset:512
s_add_u32 m0, s49, 66560
s_add_u32 s52, s46, 512
buffer_load_dwordx4 v17, s[8:11], s52 offen lds
v_mfma_f32_16x16x32_bf16 v[168:171], v[76:79], v[56:59], v[168:171]
ds_read_b128 v[28:31], v10 offset:4096
v_mfma_f32_16x16x32_bf16 v[148:151], v[72:75], v[60:63], v[148:151]
ds_read_b64_tr_b16 v[44:45], v14 offset:8192
v_mfma_f32_16x16x32_bf16 v[176:179], v[76:79], v[60:63], v[176:179]
ds_read_b64_tr_b16 v[46:47], v14 offset:8704
s_cmp_eq_u32 s66, 1
s_cbranch_scc0 SIDE_T7a0
s_cmp_eq_u32 s40, 7
s_cbranch_scc0 SIDE_T7a0
s_waitcnt vmcnt(24)
v_lshrrev_b32 v104, 3, v1
v_and_b32 v105, 7, v1
v_xor_b32 v104, v104, v105
v_lshlrev_b32 v104, 4, v104
v_lshl_add_u32 v104, v105, 10, v104
v_add_u32 v104, 151552, v104
s_mov_b32 s60, 0x05040100
s_mov_b32 s62, 0x07060302
v_perm_b32 v208, v228, v224, s60
v_perm_b32 v209, v236, v232, s60
v_perm_b32 v210, v244, v240, s60
v_perm_b32 v211, v252, v248, s60
ds_write_b128 v104, v[208:211] offset:0
v_perm_b32 v212, v228, v224, s62
v_perm_b32 v213, v236, v232, s62
v_perm_b32 v214, v244, v240, s62
v_perm_b32 v215, v252, v248, s62
ds_write_b128 v104, v[212:215] offset:128
v_perm_b32 v216, v229, v225, s60
v_perm_b32 v217, v237, v233, s60
v_perm_b32 v218, v245, v241, s60
v_perm_b32 v219, v253, v249, s60
ds_write_b128 v104, v[216:219] offset:256
v_perm_b32 v220, v229, v225, s62
v_perm_b32 v221, v237, v233, s62
v_perm_b32 v222, v245, v241, s62
v_perm_b32 v223, v253, v249, s62
ds_write_b128 v104, v[220:223] offset:384
SIDE_T7a0:
v_mfma_f32_16x16x32_bf16 v[164:167], v[80:83], v[52:55], v[164:167]
ds_read_b128 v[32:35], v10 offset:6144
v_mfma_f32_16x16x32_bf16 v[152:155], v[68:71], v[64:67], v[152:155]
ds_read_b64_tr_b16 v[48:49], v15 offset:8192
s_add_u32 m0, s49, 67584
s_add_u32 s52, s47, 512
buffer_load_dwordx4 v16, s[8:11], s52 offen lds
v_mfma_f32_16x16x32_bf16 v[172:175], v[80:83], v[56:59], v[172:175]
ds_read_b64_tr_b16 v[50:51], v15 offset:8704
v_mfma_f32_16x16x32_bf16 v[156:159], v[72:75], v[64:67], v[156:159]
v_mfma_f32_16x16x32_bf16 v[180:183], v[80:83], v[60:63], v[180:183]
v_mfma_f32_16x16x32_bf16 v[184:187], v[76:79], v[64:67], v[184:187]
v_mfma_f32_16x16x32_bf16 v[188:191], v[80:83], v[64:67], v[188:191]
s_waitcnt lgkmcnt(0)
v_mfma_f32_16x16x32_bf16 v[128:131], v[36:39], v[20:23], v[128:131]
ds_read_b128 v[52:55], v11 offset:0
s_add_u32 m0, s49, 68608
s_add_u32 s52, s48, 512
buffer_load_dwordx4 v17, s[8:11], s52 offen lds
s_cmp_eq_u32 s66, 1
s_cbranch_scc0 SIDE_T7a1
s_cmp_eq_u32 s40, 7
s_cbranch_scc0 SIDE_T7a1
s_mov_b32 s60, 0x05040100
s_mov_b32 s62, 0x07060302
v_perm_b32 v208, v230, v226, s60
v_perm_b32 v209, v238, v234, s60
v_perm_b32 v210, v246, v242, s60
v_perm_b32 v211, v254, v250, s60
ds_write_b128 v104, v[208:211] offset:512
v_perm_b32 v212, v230, v226, s62
v_perm_b32 v213, v238, v234, s62
v_perm_b32 v214, v246, v242, s62
v_perm_b32 v215, v254, v250, s62
ds_write_b128 v104, v[212:215] offset:640
v_perm_b32 v216, v231, v227, s60
v_perm_b32 v217, v239, v235, s60
v_perm_b32 v218, v247, v243, s60
v_perm_b32 v219, v255, v251, s60
ds_write_b128 v104, v[216:219] offset:768
v_perm_b32 v220, v231, v227, s62
v_perm_b32 v221, v239, v235, s62
v_perm_b32 v222, v247, v243, s62
v_perm_b32 v223, v255, v251, s62
ds_write_b128 v104, v[220:223] offset:896
SIDE_T7a1:
v_mfma_f32_16x16x32_bf16 v[132:135], v[40:43], v[20:23], v[132:135]
ds_read_b64_tr_b16 v[68:69], v14 offset:4096
v_mfma_f32_16x16x32_bf16 v[136:139], v[36:39], v[24:27], v[136:139]
ds_read_b64_tr_b16 v[70:71], v14 offset:4608
v_mfma_f32_16x16x32_bf16 v[140:143], v[40:43], v[24:27], v[140:143]
ds_read_b128 v[56:59], v11 offset:2048
v_mfma_f32_16x16x32_bf16 v[160:163], v[44:47], v[20:23], v[160:163]
ds_read_b64_tr_b16 v[72:73], v15 offset:4096
v_mfma_f32_16x16x32_bf16 v[144:147], v[36:39], v[28:31], v[144:147]
ds_read_b64_tr_b16 v[74:75], v15 offset:4608
s_add_u32 m0, s50, 32768
s_mov_b32 s52, 884736
buffer_load_dwordx4 v18, s[12:15], s52 offen lds
v_mfma_f32_16x16x32_bf16 v[168:171], v[44:47], v[24:27], v[168:171]
ds_read_b128 v[60:63], v11 offset:4096
v_mfma_f32_16x16x32_bf16 v[148:151], v[40:43], v[28:31], v[148:151]
ds_read_b64_tr_b16 v[76:77], v14 offset:12288
v_mfma_f32_16x16x32_bf16 v[176:179], v[44:47], v[28:31], v[176:179]
ds_read_b64_tr_b16 v[78:79], v14 offset:12800
s_cmp_eq_u32 s66, 1
s_cbranch_scc0 SIDE_T7b
s_cmp_eq_u32 s40, 7
s_cbranch_scc0 SIDE_T7b
v_lshrrev_b32 v105, 3, v1
v_and_b32 v106, 7, v1
v_lshlrev_b32 v104, 7, v105
v_lshl_add_u32 v104, v106, 4, v104
v_add_u32 v104, 151552, v104
v_lshlrev_b32 v105, 13, v105
v_lshl_add_u32 v105, v106, 4, v105
s_waitcnt lgkmcnt(0)
v_xor_b32 v106, 0, v104
ds_read_b128 v[224:227], v106 offset:0
v_xor_b32 v106, 16, v104
ds_read_b128 v[228:231], v106 offset:1024
v_xor_b32 v106, 32, v104
ds_read_b128 v[232:235], v106 offset:2048
v_xor_b32 v106, 48, v104
ds_read_b128 v[236:239], v106 offset:3072
v_xor_b32 v106, 64, v104
ds_read_b128 v[240:243], v106 offset:4096
v_xor_b32 v106, 80, v104
ds_read_b128 v[244:247], v106 offset:5120
v_xor_b32 v106, 96, v104
ds_read_b128 v[248:251], v106 offset:6144
v_xor_b32 v106, 112, v104
ds_read_b128 v[252:255], v106 offset:7168
SIDE_T7b:
v_mfma_f32_16x16x32_bf16 v[164:167], v[48:51], v[20:23], v[164:167]
ds_read_b128 v[64:67], v11 offset:6144
v_mfma_f32_16x16x32_bf16 v[152:155], v[36:39], v[32:35], v[152:155]
ds_read_b64_tr_b16 v[80:81], v15 offset:12288
s_add_u32 m0, s50, 40960
s_mov_b32 s52, 884736
buffer_load_dwordx4 v18, s[16:19], s52 offen lds
v_mfma_f32_16x16x32_bf16 v[172:175], v[48:51], v[24:27], v[172:175]
ds_read_b64_tr_b16 v[82:83], v15 offset:12800
v_mfma_f32_16x16x32_bf16 v[156:159], v[40:43], v[32:35], v[156:159]
v_mfma_f32_16x16x32_bf16 v[180:183], v[48:51], v[28:31], v[180:183]
v_mfma_f32_16x16x32_bf16 v[184:187], v[44:47], v[32:35], v[184:187]
v_mfma_f32_16x16x32_bf16 v[188:191], v[48:51], v[32:35], v[188:191]
s_waitcnt lgkmcnt(0)
s_waitcnt vmcnt(6)
s_barrier
v_mfma_f32_16x16x32_bf16 v[128:131], v[68:71], v[52:55], v[128:131]
ds_read_b128 v[20:23], v10 offset:32768
s_add_u32 m0, s49, 0
s_add_u32 s52, s45, 1152
buffer_load_dwordx4 v16, s[8:11], s52 offen lds
s_cmp_eq_u32 s66, 1
s_cbranch_scc0 SIDE_T7c
s_cmp_eq_u32 s40, 7
s_cbranch_scc0 SIDE_T7c
s_waitcnt lgkmcnt(0)
s_add_u32 s60, s65, 0
buffer_store_dwordx4 v[224:227], v105, s[20:23], s60 offen sc1
s_add_u32 s60, s65, 65536
buffer_store_dwordx4 v[228:231], v105, s[20:23], s60 offen sc1
s_add_u32 s60, s65, 131072
buffer_store_dwordx4 v[232:235], v105, s[20:23], s60 offen sc1
s_add_u32 s60, s65, 196608
buffer_store_dwordx4 v[236:239], v105, s[20:23], s60 offen sc1
s_add_u32 s60, s65, 262144
buffer_store_dwordx4 v[240:243], v105, s[20:23], s60 offen sc1
s_add_u32 s60, s65, 327680
buffer_store_dwordx4 v[244:247], v105, s[20:23], s60 offen sc1
s_add_u32 s60, s65, 393216
buffer_store_dwordx4 v[248:251], v105, s[20:23], s60 offen sc1
s_add_u32 s60, s65, 458752
buffer_store_dwordx4 v[252:255], v105, s[20:23], s60 offen sc1
SIDE_T7c:
v_mfma_f32_16x16x32_bf16 v[132:135], v[72:75], v[52:55], v[132:135]
ds_read_b64_tr_b16 v[36:37], v14 offset:16384
v_mfma_f32_16x16x32_bf16 v[136:139], v[68:71], v[56:59], v[136:139]
ds_read_b64_tr_b16 v[38:39], v14 offset:16896
v_mfma_f32_16x16x32_bf16 v[140:143], v[72:75], v[56:59], v[140:143]
ds_read_b128 v[24:27], v10 offset:34816
v_mfma_f32_16x16x32_bf16 v[160:163], v[76:79], v[52:55], v[160:163]
ds_read_b64_tr_b16 v[40:41], v15 offset:16384
v_mfma_f32_16x16x32_bf16 v[144:147], v[68:71], v[60:63], v[144:147]
ds_read_b64_tr_b16 v[42:43], v15 offset:16896
s_add_u32 m0, s49, 1024
s_add_u32 s52, s46, 1152
buffer_load_dwordx4 v17, s[8:11], s52 offen lds
v_mfma_f32_16x16x32_bf16 v[168:171], v[76:79], v[56:59], v[168:171]
ds_read_b128 v[28:31], v10 offset:36864
v_mfma_f32_16x16x32_bf16 v[148:151], v[72:75], v[60:63], v[148:151]
ds_read_b64_tr_b16 v[44:45], v14 offset:24576
v_mfma_f32_16x16x32_bf16 v[176:179], v[76:79], v[60:63], v[176:179]
ds_read_b64_tr_b16 v[46:47], v14 offset:25088
v_mfma_f32_16x16x32_bf16 v[164:167], v[80:83], v[52:55], v[164:167]
ds_read_b128 v[32:35], v10 offset:38912
v_mfma_f32_16x16x32_bf16 v[152:155], v[68:71], v[64:67], v[152:155]
ds_read_b64_tr_b16 v[48:49], v15 offset:24576
s_add_u32 m0, s49, 2048
s_add_u32 s52, s47, 1152
buffer_load_dwordx4 v16, s[8:11], s52 offen lds
v_mfma_f32_16x16x32_bf16 v[172:175], v[80:83], v[56:59], v[172:175]
ds_read_b64_tr_b16 v[50:51], v15 offset:25088
v_mfma_f32_16x16x32_bf16 v[156:159], v[72:75], v[64:67], v[156:159]
v_mfma_f32_16x16x32_bf16 v[180:183], v[80:83], v[60:63], v[180:183]
v_mfma_f32_16x16x32_bf16 v[184:187], v[76:79], v[64:67], v[184:187]
v_mfma_f32_16x16x32_bf16 v[188:191], v[80:83], v[64:67], v[188:191]
s_waitcnt lgkmcnt(0)
v_mfma_f32_16x16x32_bf16 v[128:131], v[36:39], v[20:23], v[128:131]
ds_read_b128 v[52:55], v11 offset:32768
s_add_u32 m0, s49, 3072
s_add_u32 s52, s48, 1152
buffer_load_dwordx4 v17, s[8:11], s52 offen lds
v_and_b32 v116, 7, v1
v_mfma_f32_16x16x32_bf16 v[132:135], v[40:43], v[20:23], v[132:135]
ds_read_b64_tr_b16 v[68:69], v14 offset:20480
v_mfma_f32_16x16x32_bf16 v[136:139], v[36:39], v[24:27], v[136:139]
ds_read_b64_tr_b16 v[70:71], v14 offset:20992
v_mfma_f32_16x16x32_bf16 v[140:143], v[40:43], v[24:27], v[140:143]
ds_read_b128 v[56:59], v11 offset:34816
v_mfma_f32_16x16x32_bf16 v[160:163], v[44:47], v[20:23], v[160:163]
ds_read_b64_tr_b16 v[72:73], v15 offset:20480
v_mfma_f32_16x16x32_bf16 v[144:147], v[36:39], v[28:31], v[144:147]
ds_read_b64_tr_b16 v[74:75], v15 offset:20992
s_add_u32 m0, s50, 0
s_mov_b32 s52, 1990656
buffer_load_dwordx4 v18, s[12:15], s52 offen lds
v_lshlrev_b32 v116, 5, v116
v_mfma_f32_16x16x32_bf16 v[168:171], v[44:47], v[24:27], v[168:171]
ds_read_b128 v[60:63], v11 offset:36864
v_mfma_f32_16x16x32_bf16 v[148:151], v[40:43], v[28:31], v[148:151]
ds_read_b64_tr_b16 v[76:77], v14 offset:28672
v_mfma_f32_16x16x32_bf16 v[176:179], v[44:47], v[28:31], v[176:179]
ds_read_b64_tr_b16 v[78:79], v14 offset:29184
v_mfma_f32_16x16x32_bf16 v[164:167], v[48:51], v[20:23], v[164:167]
ds_read_b128 v[64:67], v11 offset:38912
v_mfma_f32_16x16x32_bf16 v[152:155], v[36:39], v[32:35], v[152:155]
ds_read_b64_tr_b16 v[80:81], v15 offset:28672
s_add_u32 m0, s50, 8192
s_mov_b32 s52, 1990656
buffer_load_dwordx4 v18, s[16:19], s52 offen lds
buffer_load_dword v117, v116, s[36:39], s68 offen sc1
v_mfma_f32_16x16x32_bf16 v[172:175], v[48:51], v[24:27], v[172:175]
ds_read_b64_tr_b16 v[82:83], v15 offset:29184
v_mfma_f32_16x16x32_bf16 v[156:159], v[40:43], v[32:35], v[156:159]
v_mfma_f32_16x16x32_bf16 v[180:183], v[48:51], v[28:31], v[180:183]
v_mfma_f32_16x16x32_bf16 v[184:187], v[44:47], v[32:35], v[184:187]
v_mfma_f32_16x16x32_bf16 v[188:191], v[48:51], v[32:35], v[188:191]
s_waitcnt lgkmcnt(0)
s_waitcnt vmcnt(7)
s_barrier
v_mfma_f32_16x16x32_bf16 v[128:131], v[68:71], v[52:55], v[128:131]
ds_read_b128 v[20:23], v12 offset:0
v_mfma_f32_16x16x32_bf16 v[132:135], v[72:75], v[52:55], v[132:135]
ds_read_b64_tr_b16 v[36:37], v14 offset:32768
v_mfma_f32_16x16x32_bf16 v[136:139], v[68:71], v[56:59], v[136:139]
ds_read_b64_tr_b16 v[38:39], v14 offset:33280
v_mfma_f32_16x16x32_bf16 v[140:143], v[72:75], v[56:59], v[140:143]
ds_read_b128 v[24:27], v12 offset:2048
v_mfma_f32_16x16x32_bf16 v[160:163], v[76:79], v[52:55], v[160:163]
ds_read_b64_tr_b16 v[40:41], v15 offset:32768
v_mfma_f32_16x16x32_bf16 v[144:147], v[68:71], v[60:63], v[144:147]
ds_read_b64_tr_b16 v[42:43], v15 offset:33280
v_mfma_f32_16x16x32_bf16 v[168:171], v[76:79], v[56:59], v[168:171]
ds_read_b128 v[28:31], v12 offset:4096
v_mfma_f32_16x16x32_bf16 v[148:151], v[72:75], v[60:63], v[148:151]
ds_read_b64_tr_b16 v[44:45], v14 offset:40960
v_mfma_f32_16x16x32_bf16 v[176:179], v[76:79], v[60:63], v[176:179]
ds_read_b64_tr_b16 v[46:47], v14 offset:41472
v_mfma_f32_16x16x32_bf16 v[164:167], v[80:83], v[52:55], v[164:167]
ds_read_b128 v[32:35], v12 offset:6144
v_mfma_f32_16x16x32_bf16 v[152:155], v[68:71], v[64:67], v[152:155]
ds_read_b64_tr_b16 v[48:49], v15 offset:40960
v_mfma_f32_16x16x32_bf16 v[172:175], v[80:83], v[56:59], v[172:175]
ds_read_b64_tr_b16 v[50:51], v15 offset:41472
v_mfma_f32_16x16x32_bf16 v[156:159], v[72:75], v[64:67], v[156:159]
v_mfma_f32_16x16x32_bf16 v[180:183], v[80:83], v[60:63], v[180:183]
v_mfma_f32_16x16x32_bf16 v[184:187], v[76:79], v[64:67], v[184:187]
v_mfma_f32_16x16x32_bf16 v[188:191], v[80:83], v[64:67], v[188:191]
s_waitcnt lgkmcnt(0)
v_mfma_f32_16x16x32_bf16 v[128:131], v[36:39], v[20:23], v[128:131]
ds_read_b128 v[52:55], v13 offset:0
s_waitcnt vmcnt(0)
s_cmp_lg_u32 s40, 0
s_cbranch_scc1 K1_SPUN_G
v_cmp_ne_u32 vcc, 32, v117
s_cbranch_vccnz K1_SPIN_G
K1_SPUN_G:
v_mfma_f32_16x16x32_bf16 v[132:135], v[40:43], v[20:23], v[132:135]
ds_read_b64_tr_b16 v[68:69], v14 offset:36864
v_mfma_f32_16x16x32_bf16 v[136:139], v[36:39], v[24:27], v[136:139]
ds_read_b64_tr_b16 v[70:71], v14 offset:37376
v_mfma_f32_16x16x32_bf16 v[140:143], v[40:43], v[24:27], v[140:143]
ds_read_b128 v[56:59], v13 offset:2048
v_mfma_f32_16x16x32_bf16 v[160:163], v[44:47], v[20:23], v[160:163]
ds_read_b64_tr_b16 v[72:73], v15 offset:36864
v_mfma_f32_16x16x32_bf16 v[144:147], v[36:39], v[28:31], v[144:147]
ds_read_b64_tr_b16 v[74:75], v15 offset:37376
v_mfma_f32_16x16x32_bf16 v[168:171], v[44:47], v[24:27], v[168:171]
ds_read_b128 v[60:63], v13 offset:4096
v_mfma_f32_16x16x32_bf16 v[148:151], v[40:43], v[28:31], v[148:151]
ds_read_b64_tr_b16 v[76:77], v14 offset:45056
v_mfma_f32_16x16x32_bf16 v[176:179], v[44:47], v[28:31], v[176:179]
ds_read_b64_tr_b16 v[78:79], v14 offset:45568
v_mfma_f32_16x16x32_bf16 v[164:167], v[48:51], v[20:23], v[164:167]
ds_read_b128 v[64:67], v13 offset:6144
v_mfma_f32_16x16x32_bf16 v[152:155], v[36:39], v[32:35], v[152:155]
ds_read_b64_tr_b16 v[80:81], v15 offset:45056
v_mfma_f32_16x16x32_bf16 v[172:175], v[48:51], v[24:27], v[172:175]
ds_read_b64_tr_b16 v[82:83], v15 offset:45568
v_mfma_f32_16x16x32_bf16 v[156:159], v[40:43], v[32:35], v[156:159]
v_mfma_f32_16x16x32_bf16 v[180:183], v[48:51], v[28:31], v[180:183]
v_mfma_f32_16x16x32_bf16 v[184:187], v[44:47], v[32:35], v[184:187]
v_mfma_f32_16x16x32_bf16 v[188:191], v[48:51], v[32:35], v[188:191]
s_waitcnt lgkmcnt(0)
s_waitcnt vmcnt(6)
s_barrier
v_mfma_f32_16x16x32_bf16 v[128:131], v[68:71], v[52:55], v[128:131]
ds_read_b128 v[20:23], v10 offset:0
v_and_b32 v116, 31, v1
s_lshl_b32 s53, s40, 5
v_mfma_f32_16x16x32_bf16 v[132:135], v[72:75], v[52:55], v[132:135]
ds_read_b64_tr_b16 v[36:37], v14 offset:0
v_add_u32 v116, s53, v116
v_mfma_f32_16x16x32_bf16 v[136:139], v[68:71], v[56:59], v[136:139]
ds_read_b64_tr_b16 v[38:39], v14 offset:512
s_lshl_b32 s54, s41, 11
v_mfma_f32_16x16x32_bf16 v[140:143], v[72:75], v[56:59], v[140:143]
ds_read_b128 v[24:27], v10 offset:2048
v_lshlrev_b32 v118, 3, v116
v_mfma_f32_16x16x32_bf16 v[160:163], v[76:79], v[52:55], v[160:163]
ds_read_b64_tr_b16 v[40:41], v15 offset:0
s_add_u32 s54, s54, 0
v_mfma_f32_16x16x32_bf16 v[144:147], v[68:71], v[60:63], v[144:147]
ds_read_b64_tr_b16 v[42:43], v15 offset:512
buffer_load_dwordx2 v[120:121], v118, s[20:23], s54 offen sc1
v_mfma_f32_16x16x32_bf16 v[168:171], v[76:79], v[56:59], v[168:171]
ds_read_b128 v[28:31], v10 offset:4096
v_and_b32 v119, 15, v1
v_mfma_f32_16x16x32_bf16 v[148:151], v[72:75], v[60:63], v[148:151]
ds_read_b64_tr_b16 v[44:45], v14 offset:8192
v_lshrrev_b32 v122, 4, v1
v_mfma_f32_16x16x32_bf16 v[176:179], v[76:79], v[60:63], v[176:179]
ds_read_b64_tr_b16 v[46:47], v14 offset:8704
v_lshlrev_b32 v122, 9, v122
v_lshl_add_u32 v122, v119, 2, v122
v_mfma_f32_16x16x32_bf16 v[164:167], v[80:83], v[52:55], v[164:167]
ds_read_b128 v[32:35], v10 offset:6144
s_lshl_b32 s53, s40, 6
v_mfma_f32_16x16x32_bf16 v[152:155], v[68:71], v[64:67], v[152:155]
ds_read_b64_tr_b16 v[48:49], v15 offset:8192
s_lshl_b32 s54, s42, 12
v_mfma_f32_16x16x32_bf16 v[172:175], v[80:83], v[56:59], v[172:175]
ds_read_b64_tr_b16 v[50:51], v15 offset:8704
s_add_u32 s54, s54, s53
v_mfma_f32_16x16x32_bf16 v[156:159], v[72:75], v[64:67], v[156:159]
s_add_u32 s54, s54, 65536
v_mfma_f32_16x16x32_bf16 v[180:183], v[80:83], v[60:63], v[180:183]
buffer_load_dword v123, v122, s[20:23], s54 offen sc1
v_mfma_f32_16x16x32_bf16 v[184:187], v[76:79], v[64:67], v[184:187]
buffer_load_dword v124, v122, s[20:23], s54 offen offset:2048 sc1
v_mfma_f32_16x16x32_bf16 v[188:191], v[80:83], v[64:67], v[188:191]
s_lshl_b32 s53, s41, 7
s_add_u32 s53, s53, s68
s_add_u32 s53, s53, 294912
v_mov_b32 v126, 1
v_lshlrev_b32 v127, 10, v1
s_mov_b64 exec, 0xff
buffer_atomic_add v126, v127, s[20:23], s53 offen
s_mov_b64 exec, -1
s_waitcnt lgkmcnt(0)
v_mfma_f32_16x16x32_bf16 v[128:131], v[36:39], v[20:23], v[128:131]
ds_read_b128 v[52:55], v11 offset:0
v_mfma_f32_16x16x32_bf16 v[132:135], v[40:43], v[20:23], v[132:135]
ds_read_b64_tr_b16 v[68:69], v14 offset:4096
v_mfma_f32_16x16x32_bf16 v[136:139], v[36:39], v[24:27], v[136:139]
ds_read_b64_tr_b16 v[70:71], v14 offset:4608
v_mfma_f32_16x16x32_bf16 v[140:143], v[40:43], v[24:27], v[140:143]
ds_read_b128 v[56:59], v11 offset:2048
v_mfma_f32_16x16x32_bf16 v[160:163], v[44:47], v[20:23], v[160:163]
ds_read_b64_tr_b16 v[72:73], v15 offset:4096
v_mfma_f32_16x16x32_bf16 v[144:147], v[36:39], v[28:31], v[144:147]
ds_read_b64_tr_b16 v[74:75], v15 offset:4608
v_mfma_f32_16x16x32_bf16 v[168:171], v[44:47], v[24:27], v[168:171]
ds_read_b128 v[60:63], v11 offset:4096
v_mfma_f32_16x16x32_bf16 v[148:151], v[40:43], v[28:31], v[148:151]
ds_read_b64_tr_b16 v[76:77], v14 offset:12288
v_mfma_f32_16x16x32_bf16 v[176:179], v[44:47], v[28:31], v[176:179]
ds_read_b64_tr_b16 v[78:79], v14 offset:12800
v_mfma_f32_16x16x32_bf16 v[164:167], v[48:51], v[20:23], v[164:167]
ds_read_b128 v[64:67], v11 offset:6144
v_mfma_f32_16x16x32_bf16 v[152:155], v[36:39], v[32:35], v[152:155]
ds_read_b64_tr_b16 v[80:81], v15 offset:12288
v_mfma_f32_16x16x32_bf16 v[172:175], v[48:51], v[24:27], v[172:175]
ds_read_b64_tr_b16 v[82:83], v15 offset:12800
v_mfma_f32_16x16x32_bf16 v[156:159], v[40:43], v[32:35], v[156:159]
v_mfma_f32_16x16x32_bf16 v[180:183], v[48:51], v[28:31], v[180:183]
v_mfma_f32_16x16x32_bf16 v[184:187], v[44:47], v[32:35], v[184:187]
v_mfma_f32_16x16x32_bf16 v[188:191], v[48:51], v[32:35], v[188:191]
s_waitcnt lgkmcnt(0)
s_barrier
v_mfma_f32_16x16x32_bf16 v[128:131], v[68:71], v[52:55], v[128:131]
v_mfma_f32_16x16x32_bf16 v[132:135], v[72:75], v[52:55], v[132:135]
v_mfma_f32_16x16x32_bf16 v[136:139], v[68:71], v[56:59], v[136:139]
v_mfma_f32_16x16x32_bf16 v[140:143], v[72:75], v[56:59], v[140:143]
v_mfma_f32_16x16x32_bf16 v[160:163], v[76:79], v[52:55], v[160:163]
v_mfma_f32_16x16x32_bf16 v[144:147], v[68:71], v[60:63], v[144:147]
v_mfma_f32_16x16x32_bf16 v[168:171], v[76:79], v[56:59], v[168:171]
v_mfma_f32_16x16x32_bf16 v[148:151], v[72:75], v[60:63], v[148:151]
v_mfma_f32_16x16x32_bf16 v[176:179], v[76:79], v[60:63], v[176:179]
v_mfma_f32_16x16x32_bf16 v[164:167], v[80:83], v[52:55], v[164:167]
v_mfma_f32_16x16x32_bf16 v[152:155], v[68:71], v[64:67], v[152:155]
v_mfma_f32_16x16x32_bf16 v[172:175], v[80:83], v[56:59], v[172:175]
v_mfma_f32_16x16x32_bf16 v[156:159], v[72:75], v[64:67], v[156:159]
v_mfma_f32_16x16x32_bf16 v[180:183], v[80:83], v[60:63], v[180:183]
v_mfma_f32_16x16x32_bf16 v[184:187], v[76:79], v[64:67], v[184:187]
v_mfma_f32_16x16x32_bf16 v[188:191], v[80:83], v[64:67], v[188:191]
s_waitcnt vmcnt(1)
v_mul_f32 v121, v121, v121
v_lshlrev_b32 v118, 3, v116
v_add_u32 v118, 147456, v118
ds_write_b64 v118, v[120:121]
v_add_f32 v123, v123, v124
v_mov_b32 v124, v123
s_nop 1
v_permlane16_swap_b32 v124, v123
v_add_f32 v123, v123, v124
v_mov_b32 v124, v123
s_nop 1
v_permlane32_swap_b32 v124, v123
v_add_f32 v123, v123, v124
s_lshl_b32 s53, s40, 6
s_add_u32 s53, s53, 149504
v_lshl_add_u32 v119, v119, 2, s53
ds_write_b32 v119, v123
s_waitcnt lgkmcnt(0)
s_barrier
v_and_b32 v2, 15, v1
v_lshrrev_b32 v3, 4, v1
s_lshl_b32 s53, s43, 9
s_add_u32 s53, s53, 147456
v_lshl_add_u32 v4, v2, 3, s53
s_lshl_b32 s53, s44, 7
s_add_u32 s53, s53, 149504
v_lshl_add_u32 v5, v3, 4, s53
ds_read_b64 v[20:21], v4 offset:0
ds_read_b64 v[22:23], v4 offset:128
ds_read_b64 v[24:25], v4 offset:256
ds_read_b64 v[26:27], v4 offset:384
ds_read_b128 v[28:31], v5 offset:0
ds_read_b128 v[36:39], v5 offset:256
ds_read_b128 v[32:35], v5 offset:64
ds_read_b128 v[40:43], v5 offset:320
s_lshl_b32 s53, s41, 4
s_lshl_b32 s54, s43, 2
s_add_u32 s53, s53, s54
s_mul_i32 s53, s53, 54
s_lshl_b32 s54, s42, 1
s_add_u32 s53, s53, s54
s_add_u32 s53, s53, s44
s_lshl_b32 s53, s53, 10
s_add_u32 s53, s53, 1048576
v_lshlrev_b32 v6, 4, v1
s_waitcnt lgkmcnt(0)
v_pk_fma_f32 v[128:129], v[20:21], v[28:29], v[128:129] op_sel_hi:[0,1,1] neg_lo:[1,0,0] neg_hi:[1,0,0]
v_pk_fma_f32 v[160:161], v[20:21], v[36:37], v[160:161] op_sel_hi:[0,1,1] neg_lo:[1,0,0] neg_hi:[1,0,0]
v_pk_mul_f32 v[128:129], v[128:129], v[20:21] op_sel:[0,1] op_sel_hi:[1,1]
v_pk_mul_f32 v[128:129], v[128:129], v[160:161]
v_cvt_pk_bf16_f32 v44, v128, v129
v_pk_fma_f32 v[130:131], v[20:21], v[30:31], v[130:131] op_sel_hi:[0,1,1] neg_lo:[1,0,0] neg_hi:[1,0,0]
v_pk_fma_f32 v[162:163], v[20:21], v[38:39], v[162:163] op_sel_hi:[0,1,1] neg_lo:[1,0,0] neg_hi:[1,0,0]
v_pk_mul_f32 v[130:131], v[130:131], v[20:21] op_sel:[0,1] op_sel_hi:[1,1]
v_pk_mul_f32 v[130:131], v[130:131], v[162:163]
v_cvt_pk_bf16_f32 v45, v130, v131
v_pk_fma_f32 v[132:133], v[20:21], v[32:33], v[132:133] op_sel_hi:[0,1,1] neg_lo:[1,0,0] neg_hi:[1,0,0]
v_pk_fma_f32 v[164:165], v[20:21], v[40:41], v[164:165] op_sel_hi:[0,1,1] neg_lo:[1,0,0] neg_hi:[1,0,0]
v_pk_mul_f32 v[132:133], v[132:133], v[20:21] op_sel:[0,1] op_sel_hi:[1,1]
v_pk_mul_f32 v[132:133], v[132:133], v[164:165]
v_cvt_pk_bf16_f32 v46, v132, v133
v_pk_fma_f32 v[134:135], v[20:21], v[34:35], v[134:135] op_sel_hi:[0,1,1] neg_lo:[1,0,0] neg_hi:[1,0,0]
v_pk_fma_f32 v[166:167], v[20:21], v[42:43], v[166:167] op_sel_hi:[0,1,1] neg_lo:[1,0,0] neg_hi:[1,0,0]
v_pk_mul_f32 v[134:135], v[134:135], v[20:21] op_sel:[0,1] op_sel_hi:[1,1]
v_pk_mul_f32 v[134:135], v[134:135], v[166:167]
v_cvt_pk_bf16_f32 v47, v134, v135
buffer_store_dwordx4 v[44:47], v6, s[20:23], s53 offen sc1
s_add_u32 s53, s53, 55296
v_pk_fma_f32 v[136:137], v[22:23], v[28:29], v[136:137] op_sel_hi:[0,1,1] neg_lo:[1,0,0] neg_hi:[1,0,0]
v_pk_fma_f32 v[168:169], v[22:23], v[36:37], v[168:169] op_sel_hi:[0,1,1] neg_lo:[1,0,0] neg_hi:[1,0,0]
v_pk_mul_f32 v[136:137], v[136:137], v[22:23] op_sel:[0,1] op_sel_hi:[1,1]
v_pk_mul_f32 v[136:137], v[136:137], v[168:169]
v_cvt_pk_bf16_f32 v48, v136, v137
v_pk_fma_f32 v[138:139], v[22:23], v[30:31], v[138:139] op_sel_hi:[0,1,1] neg_lo:[1,0,0] neg_hi:[1,0,0]
v_pk_fma_f32 v[170:171], v[22:23], v[38:39], v[170:171] op_sel_hi:[0,1,1] neg_lo:[1,0,0] neg_hi:[1,0,0]
v_pk_mul_f32 v[138:139], v[138:139], v[22:23] op_sel:[0,1] op_sel_hi:[1,1]
v_pk_mul_f32 v[138:139], v[138:139], v[170:171]
v_cvt_pk_bf16_f32 v49, v138, v139
v_pk_fma_f32 v[140:141], v[22:23], v[32:33], v[140:141] op_sel_hi:[0,1,1] neg_lo:[1,0,0] neg_hi:[1,0,0]
v_pk_fma_f32 v[172:173], v[22:23], v[40:41], v[172:173] op_sel_hi:[0,1,1] neg_lo:[1,0,0] neg_hi:[1,0,0]
v_pk_mul_f32 v[140:141], v[140:141], v[22:23] op_sel:[0,1] op_sel_hi:[1,1]
v_pk_mul_f32 v[140:141], v[140:141], v[172:173]
v_cvt_pk_bf16_f32 v50, v140, v141
v_pk_fma_f32 v[142:143], v[22:23], v[34:35], v[142:143] op_sel_hi:[0,1,1] neg_lo:[1,0,0] neg_hi:[1,0,0]
v_pk_fma_f32 v[174:175], v[22:23], v[42:43], v[174:175] op_sel_hi:[0,1,1] neg_lo:[1,0,0] neg_hi:[1,0,0]
v_pk_mul_f32 v[142:143], v[142:143], v[22:23] op_sel:[0,1] op_sel_hi:[1,1]
v_pk_mul_f32 v[142:143], v[142:143], v[174:175]
v_cvt_pk_bf16_f32 v51, v142, v143
buffer_store_dwordx4 v[48:51], v6, s[20:23], s53 offen sc1
s_add_u32 s53, s53, 55296
v_pk_fma_f32 v[144:145], v[24:25], v[28:29], v[144:145] op_sel_hi:[0,1,1] neg_lo:[1,0,0] neg_hi:[1,0,0]
v_pk_fma_f32 v[176:177], v[24:25], v[36:37], v[176:177] op_sel_hi:[0,1,1] neg_lo:[1,0,0] neg_hi:[1,0,0]
v_pk_mul_f32 v[144:145], v[144:145], v[24:25] op_sel:[0,1] op_sel_hi:[1,1]
v_pk_mul_f32 v[144:145], v[144:145], v[176:177]
v_cvt_pk_bf16_f32 v52, v144, v145
v_pk_fma_f32 v[146:147], v[24:25], v[30:31], v[146:147] op_sel_hi:[0,1,1] neg_lo:[1,0,0] neg_hi:[1,0,0]
v_pk_fma_f32 v[178:179], v[24:25], v[38:39], v[178:179] op_sel_hi:[0,1,1] neg_lo:[1,0,0] neg_hi:[1,0,0]
v_pk_mul_f32 v[146:147], v[146:147], v[24:25] op_sel:[0,1] op_sel_hi:[1,1]
v_pk_mul_f32 v[146:147], v[146:147], v[178:179]
v_cvt_pk_bf16_f32 v53, v146, v147
v_pk_fma_f32 v[148:149], v[24:25], v[32:33], v[148:149] op_sel_hi:[0,1,1] neg_lo:[1,0,0] neg_hi:[1,0,0]
v_pk_fma_f32 v[180:181], v[24:25], v[40:41], v[180:181] op_sel_hi:[0,1,1] neg_lo:[1,0,0] neg_hi:[1,0,0]
v_pk_mul_f32 v[148:149], v[148:149], v[24:25] op_sel:[0,1] op_sel_hi:[1,1]
v_pk_mul_f32 v[148:149], v[148:149], v[180:181]
v_cvt_pk_bf16_f32 v54, v148, v149
v_pk_fma_f32 v[150:151], v[24:25], v[34:35], v[150:151] op_sel_hi:[0,1,1] neg_lo:[1,0,0] neg_hi:[1,0,0]
v_pk_fma_f32 v[182:183], v[24:25], v[42:43], v[182:183] op_sel_hi:[0,1,1] neg_lo:[1,0,0] neg_hi:[1,0,0]
v_pk_mul_f32 v[150:151], v[150:151], v[24:25] op_sel:[0,1] op_sel_hi:[1,1]
v_pk_mul_f32 v[150:151], v[150:151], v[182:183]
v_cvt_pk_bf16_f32 v55, v150, v151
buffer_store_dwordx4 v[52:55], v6, s[20:23], s53 offen sc1
s_add_u32 s53, s53, 55296
v_pk_fma_f32 v[152:153], v[26:27], v[28:29], v[152:153] op_sel_hi:[0,1,1] neg_lo:[1,0,0] neg_hi:[1,0,0]
v_pk_fma_f32 v[184:185], v[26:27], v[36:37], v[184:185] op_sel_hi:[0,1,1] neg_lo:[1,0,0] neg_hi:[1,0,0]
v_pk_mul_f32 v[152:153], v[152:153], v[26:27] op_sel:[0,1] op_sel_hi:[1,1]
v_pk_mul_f32 v[152:153], v[152:153], v[184:185]
v_cvt_pk_bf16_f32 v56, v152, v153
v_pk_fma_f32 v[154:155], v[26:27], v[30:31], v[154:155] op_sel_hi:[0,1,1] neg_lo:[1,0,0] neg_hi:[1,0,0]
v_pk_fma_f32 v[186:187], v[26:27], v[38:39], v[186:187] op_sel_hi:[0,1,1] neg_lo:[1,0,0] neg_hi:[1,0,0]
v_pk_mul_f32 v[154:155], v[154:155], v[26:27] op_sel:[0,1] op_sel_hi:[1,1]
v_pk_mul_f32 v[154:155], v[154:155], v[186:187]
v_cvt_pk_bf16_f32 v57, v154, v155
v_pk_fma_f32 v[156:157], v[26:27], v[32:33], v[156:157] op_sel_hi:[0,1,1] neg_lo:[1,0,0] neg_hi:[1,0,0]
v_pk_fma_f32 v[188:189], v[26:27], v[40:41], v[188:189] op_sel_hi:[0,1,1] neg_lo:[1,0,0] neg_hi:[1,0,0]
v_pk_mul_f32 v[156:157], v[156:157], v[26:27] op_sel:[0,1] op_sel_hi:[1,1]
v_pk_mul_f32 v[156:157], v[156:157], v[188:189]
v_cvt_pk_bf16_f32 v58, v156, v157
v_pk_fma_f32 v[158:159], v[26:27], v[34:35], v[158:159] op_sel_hi:[0,1,1] neg_lo:[1,0,0] neg_hi:[1,0,0]
v_pk_fma_f32 v[190:191], v[26:27], v[42:43], v[190:191] op_sel_hi:[0,1,1] neg_lo:[1,0,0] neg_hi:[1,0,0]
v_pk_mul_f32 v[158:159], v[158:159], v[26:27] op_sel:[0,1] op_sel_hi:[1,1]
v_pk_mul_f32 v[158:159], v[158:159], v[190:191]
v_cvt_pk_bf16_f32 v59, v158, v159
buffer_store_dwordx4 v[56:59], v6, s[20:23], s53 offen sc1
s_branch PHASE2
K1_SPIN_G:
s_mov_b32 s53, 0
K1_SPINL_G:
s_sleep 8
buffer_load_dword v117, v116, s[36:39], 0 offen sc1
s_add_u32 s53, s53, 1
s_waitcnt vmcnt(0)
v_cmp_ne_u32 vcc, 32, v117
s_cmp_ge_u32 s53, 100000
s_cbranch_scc1 K1_SPUN_G
s_cbranch_vccz K1_SPUN_G
s_branch K1_SPINL_G
K1_DFT:
v_and_b32 v2, 7, v1
v_lshrrev_b32 v3, 4, v1
v_xor_b32 v2, v2, v3
v_lshlrev_b32 v2, 4, v2
v_bfe_u32 v4, v1, 3, 2
v_lshlrev_b32 v4, 6, v4
v_lshrrev_b32 v5, 5, v1
v_add_u32 v4, v4, v5
v_mul_u32_u24 v4, 1280, v4
v_add_u32 v16, v4, v2
s_and_b32 s52, s41, 1
s_lshl_b32 s52, s52, 5
s_bfe_u32 s53, s41, 0x10001
s_lshl_b32 s53, s53, 8
s_add_u32 s52, s52, s53
s_lshr_b32 s53, s41, 2
s_lshl_b32 s53, s53, 10
s_add_u32 s52, s52, s53
s_lshl_b32 s53, s43, 3
s_add_u32 s52, s52, s53
s_lshl_b32 s53, s44, 2
s_add_u32 s52, s52, s53
s_mul_i32 s45, s52, 1280
s_add_u32 s46, s45, 2560
s_add_u32 s47, s45, 655360
s_add_u32 s48, s45, 657920
v_xor_b32 v17, 64, v16
s_add_u32 m0, s49, 0
s_add_u32 s52, s45, 0
buffer_load_dwordx4 v16, s[8:11], s52 offen lds
s_add_u32 m0, s49, 1024
s_add_u32 s52, s46, 0
buffer_load_dwordx4 v17, s[8:11], s52 offen lds
s_add_u32 m0, s49, 2048
s_add_u32 s52, s47, 0
buffer_load_dwordx4 v16, s[8:11], s52 offen lds
s_add_u32 m0, s49, 3072
s_add_u32 s52, s48, 0
buffer_load_dwordx4 v17, s[8:11], s52 offen lds
s_barrier
s_add_u32 m0, s49, 32768
s_add_u32 s52, s45, 640
buffer_load_dwordx4 v16, s[8:11], s52 offen lds
s_add_u32 m0, s49, 33792
s_add_u32 s52, s46, 640
buffer_load_dwordx4 v17, s[8:11], s52 offen lds
s_add_u32 m0, s49, 34816
s_add_u32 s52, s47, 640
buffer_load_dwordx4 v16, s[8:11], s52 offen lds
s_add_u32 m0, s49, 35840
s_add_u32 s52, s48, 640
buffer_load_dwordx4 v17, s[8:11], s52 offen lds
s_lshl_b32 s53, s41, 8
s_lshl_b32 s54, s42, 3
s_add_u32 s53, s53, s54
s_add_u32 s53, s53, s40
s_mul_i32 s54, s53, 1280
s_lshl_b32 s77, s53, 3
v_lshlrev_b32 v2, 4, v1
v_lshlrev_b32 v3, 2, v1
buffer_load_dwordx4 v[116:119], v2, s[8:11], s54 offen
buffer_load_dword v120, v3, s[8:11], s54 offen offset:1024
v_and_b32 v2, 15, v1
v_lshrrev_b32 v3, 4, v1
v_lshrrev_b32 v4, 1, v2
v_xor_b32 v4, v4, v3
v_lshlrev_b32 v4, 4, v4
s_lshl_b32 s52, s43, 13
v_lshl_add_u32 v4, v2, 7, v4
v_add_u32 v10, s52, v4
v_xor_b32 v11, 64, v10
v_add_u32 v12, 0x10000, v10
v_add_u32 v13, 0x10000, v11
s_lshl_b32 s52, s44, 11
s_add_u32 s52, s52, 98304
v_lshlrev_b32 v4, 4, v1
v_add_u32 v14, s52, v4
s_cmp_eq_u32 s40, 0
s_cselect_b32 s68, 0, 0x40000000
s_sub_u32 s53, s42, 27
s_lshl_b32 s53, s53, 6
s_and_b32 s54, s40, 3
s_lshl_b32 s54, s54, 4
s_add_u32 s53, s53, s54
v_and_b32 v2, 15, v1
v_add_u32 v2, s53, v2
v_cvt_f32_u32 v3, v2
v_cmp_eq_u32 s[78:79], 0, v2
s_lshr_b32 s54, s40, 2
s_lshl_b32 s54, s54, 5
v_lshrrev_b32 v4, 4, v1
v_lshl_add_u32 v4, v4, 3, s54
v_cvt_f32_u32 v4, v4
s_mov_b32 s55, 0xc4200000
v_mul_f32 v6, 1.0, v3
v_mul_f32 v5, 0x3acccccd, v6
v_floor_f32 v5, v5
v_fma_f32 v5, v5, s55, v6
v_mul_f32 v5, 0x3acccccd, v5
v_cos_f32 v84, v5
v_sin_f32 v85, v5
v_mul_f32 v6, 2.0, v3
v_mul_f32 v5, 0x3acccccd, v6
v_floor_f32 v5, v5
v_fma_f32 v5, v5, s55, v6
v_mul_f32 v5, 0x3acccccd, v5
v_cos_f32 v86, v5
v_sin_f32 v87, v5
v_mul_f32 v6, 0x40400000, v3
v_mul_f32 v5, 0x3acccccd, v6
v_floor_f32 v5, v5
v_fma_f32 v5, v5, s55, v6
v_mul_f32 v5, 0x3acccccd, v5
v_cos_f32 v88, v5
v_sin_f32 v89, v5
v_mul_f32 v6, 4.0, v3
v_mul_f32 v5, 0x3acccccd, v6
v_floor_f32 v5, v5
v_fma_f32 v5, v5, s55, v6
v_mul_f32 v5, 0x3acccccd, v5
v_cos_f32 v90, v5
v_sin_f32 v91, v5
v_mul_f32 v6, 0x40a00000, v3
v_mul_f32 v5, 0x3acccccd, v6
v_floor_f32 v5, v5
v_fma_f32 v5, v5, s55, v6
v_mul_f32 v5, 0x3acccccd, v5
v_cos_f32 v92, v5
v_sin_f32 v93, v5
v_mul_f32 v6, 0x40c00000, v3
v_mul_f32 v5, 0x3acccccd, v6
v_floor_f32 v5, v5
v_fma_f32 v5, v5, s55, v6
v_mul_f32 v5, 0x3acccccd, v5
v_cos_f32 v94, v5
v_sin_f32 v95, v5
v_mul_f32 v6, 0x40e00000, v3
v_mul_f32 v5, 0x3acccccd, v6
v_floor_f32 v5, v5
v_fma_f32 v5, v5, s55, v6
v_mul_f32 v5, 0x3acccccd, v5
v_cos_f32 v96, v5
v_sin_f32 v97, v5
v_mul_f32 v6, v3, v4
v_mul_f32 v5, 0x3acccccd, v6
v_floor_f32 v5, v5
v_fma_f32 v5, v5, s55, v6
v_mul_f32 v5, 0x3acccccd, v5
v_cos_f32 v98, v5
v_sin_f32 v99, v5
s_nop 0
v_sub_f32 v99, 0, v99
v_mul_f32 v6, 0x42800000, v3
v_mul_f32 v5, 0x3acccccd, v6
v_floor_f32 v5, v5
v_fma_f32 v5, v5, s55, v6
v_mul_f32 v5, 0x3acccccd, v5
v_cos_f32 v100, v5
v_sin_f32 v101, v5
s_lshr_b32 s53, s40, 2
s_lshl_b32 s53, s53, 13
s_and_b32 s54, s40, 3
s_lshl_b32 s54, s54, 10
s_add_u32 s53, s53, s54
s_add_u32 s53, s53, 98304
v_lshlrev_b32 v5, 4, v1
v_add_u32 v102, s53, v5
v_mov_b32 v103, 0xbf803f80
v_mul_f32 v113, v98, v84
v_mul_f32 v115, v99, v84
v_fmac_f32 v113, v99, v85
v_fma_f32 v115, -v98, v85, v115
v_cvt_pk_bf16_f32 v104, v98, v113
v_cvt_pk_bf16_f32 v108, v99, v115
v_cndmask_b32 v108, v108, v103, s[78:79]
v_mul_f32 v112, v98, v86
v_mul_f32 v114, v99, v86
v_fmac_f32 v112, v99, v87
v_fma_f32 v114, -v98, v87, v114
v_mul_f32 v113, v98, v88
v_mul_f32 v115, v99, v88
v_fmac_f32 v113, v99, v89
v_fma_f32 v115, -v98, v89, v115
v_cvt_pk_bf16_f32 v105, v112, v113
v_cvt_pk_bf16_f32 v109, v114, v115
v_cndmask_b32 v109, v109, v103, s[78:79]
v_mul_f32 v112, v98, v90
v_mul_f32 v114, v99, v90
v_fmac_f32 v112, v99, v91
v_fma_f32 v114, -v98, v91, v114
v_mul_f32 v113, v98, v92
v_mul_f32 v115, v99, v92
v_fmac_f32 v113, v99, v93
v_fma_f32 v115, -v98, v93, v115
v_cvt_pk_bf16_f32 v106, v112, v113
v_cvt_pk_bf16_f32 v110, v114, v115
v_cndmask_b32 v110, v110, v103, s[78:79]
v_mul_f32 v112, v98, v94
v_mul_f32 v114, v99, v94
v_fmac_f32 v112, v99, v95
v_fma_f32 v114, -v98, v95, v114
v_mul_f32 v113, v98, v96
v_mul_f32 v115, v99, v96
v_fmac_f32 v113, v99, v97
v_fma_f32 v115, -v98, v97, v115
v_cvt_pk_bf16_f32 v107, v112, v113
v_cvt_pk_bf16_f32 v111, v114, v115
v_cndmask_b32 v111, v111, v103, s[78:79]
ds_write_b128 v102, v[104:107] offset:0
ds_write_b128 v102, v[108:111] offset:4096
v_mul_f32 v112, v98, v100
v_mul_f32 v113, v99, v100
v_fmac_f32 v112, v99, v101
v_fma_f32 v99, -v98, v101, v113
v_mov_b32 v98, v112
s_waitcnt lgkmcnt(0)
s_waitcnt vmcnt(6)
s_barrier
ds_read_b128 v[20:23], v10 offset:0
ds_read_b128 v[36:39], v14 offset:0
ds_read_b128 v[24:27], v10 offset:2048
ds_read_b128 v[40:43], v14 offset:1024
ds_read_b128 v[28:31], v10 offset:4096
ds_read_b128 v[44:47], v14 offset:4096
ds_read_b128 v[32:35], v10 offset:6144
ds_read_b128 v[48:51], v14 offset:5120
s_waitcnt lgkmcnt(0)
v_mfma_f32_16x16x32_bf16 v[128:131], v[20:23], v[36:39], 0
ds_read_b128 v[52:55], v11 offset:0
s_add_u32 m0, s49, 65536
s_add_u32 s52, s45, 128
buffer_load_dwordx4 v16, s[8:11], s52 offen lds
s_lshl_b32 s54, s2, 7
s_add_u32 s53, s68, s54
s_add_u32 s53, s53, 262144
v_mov_b32 v126, 0
v_lshlrev_b32 v127, 15, v1
s_mov_b64 exec, 3
buffer_store_dword v126, v127, s[20:23], s53 offen sc1
s_mov_b64 exec, -1
v_mfma_f32_16x16x32_bf16 v[132:135], v[20:23], v[40:43], 0
ds_read_b128 v[68:71], v14 offset:8192
s_cmp_lt_u32 s2, 4
s_cselect_b32 s53, 0, 0x40000000
v_mfma_f32_16x16x32_bf16 v[144:147], v[24:27], v[36:39], 0
s_or_b32 s53, s53, s68
v_mfma_f32_16x16x32_bf16 v[148:151], v[24:27], v[40:43], 0
ds_read_b128 v[56:59], v11 offset:2048
v_mfma_f32_16x16x32_bf16 v[136:139], v[20:23], v[44:47], 0
ds_read_b128 v[72:75], v14 offset:9216
s_add_u32 m0, s49, 66560
s_add_u32 s52, s46, 128
buffer_load_dwordx4 v17, s[8:11], s52 offen lds
s_lshl_b32 s54, s2, 10
v_mfma_f32_16x16x32_bf16 v[160:163], v[28:31], v[36:39], 0
s_add_u32 s53, s53, s54
v_mfma_f32_16x16x32_bf16 v[152:155], v[24:27], v[44:47], 0
ds_read_b128 v[60:63], v11 offset:4096
s_add_u32 s53, s53, 19922944
v_mfma_f32_16x16x32_bf16 v[164:167], v[28:31], v[40:43], 0
ds_read_b128 v[76:79], v14 offset:12288
v_mfma_f32_16x16x32_bf16 v[168:171], v[28:31], v[44:47], 0
s_add_u32 m0, s49, 67584
s_add_u32 s52, s47, 128
buffer_load_dwordx4 v16, s[8:11], s52 offen lds
v_mov_b32 v124, 0
v_mfma_f32_16x16x32_bf16 v[140:143], v[20:23], v[48:51], 0
ds_read_b128 v[64:67], v11 offset:6144
v_mov_b32 v125, 0
v_mfma_f32_16x16x32_bf16 v[176:179], v[32:35], v[36:39], 0
ds_read_b128 v[80:83], v14 offset:13312
v_mov_b32 v126, 0
v_mfma_f32_16x16x32_bf16 v[156:159], v[24:27], v[48:51], 0
v_mfma_f32_16x16x32_bf16 v[180:183], v[32:35], v[40:43], 0
s_add_u32 m0, s49, 68608
s_add_u32 s52, s48, 128
buffer_load_dwordx4 v17, s[8:11], s52 offen lds
v_mov_b32 v127, 0
v_mfma_f32_16x16x32_bf16 v[172:175], v[28:31], v[48:51], 0
v_lshlrev_b32 v121, 4, v1
v_mfma_f32_16x16x32_bf16 v[184:187], v[32:35], v[44:47], 0
buffer_store_dwordx4 v[124:127], v121, s[20:23], s53 offen sc1
v_mfma_f32_16x16x32_bf16 v[188:191], v[32:35], v[48:51], 0
s_waitcnt lgkmcnt(0)
s_waitcnt vmcnt(8)
s_barrier
v_mfma_f32_16x16x32_bf16 v[128:131], v[52:55], v[68:71], v[128:131]
ds_read_b128 v[20:23], v10 offset:32768
s_add_u32 m0, s49, 0
s_add_u32 s52, s45, 768
buffer_load_dwordx4 v16, s[8:11], s52 offen lds
s_waitcnt vmcnt(7)
v_mov_b32 v122, 0
v_mov_b32 v123, 0
v_lshlrev_b32 v2, 16, v116
v_and_b32 v3, 0xffff0000, v116
v_add_f32 v122, v122, v2
v_mfma_f32_16x16x32_bf16 v[132:135], v[52:55], v[72:75], v[132:135]
ds_read_b128 v[36:39], v14 offset:0
v_fmac_f32 v123, v2, v2
v_add_f32 v122, v122, v3
v_fmac_f32 v123, v3, v3
v_lshlrev_b32 v2, 16, v117
v_and_b32 v3, 0xffff0000, v117
v_mfma_f32_16x16x32_bf16 v[144:147], v[56:59], v[68:71], v[144:147]
v_add_f32 v122, v122, v2
v_fmac_f32 v123, v2, v2
v_add_f32 v122, v122, v3
v_fmac_f32 v123, v3, v3
v_lshlrev_b32 v2, 16, v118
v_mfma_f32_16x16x32_bf16 v[148:151], v[56:59], v[72:75], v[148:151]
ds_read_b128 v[24:27], v10 offset:34816
v_and_b32 v3, 0xffff0000, v118
v_add_f32 v122, v122, v2
v_fmac_f32 v123, v2, v2
v_add_f32 v122, v122, v3
v_fmac_f32 v123, v3, v3
v_mfma_f32_16x16x32_bf16 v[136:139], v[52:55], v[76:79], v[136:139]
ds_read_b128 v[40:43], v14 offset:1024
v_lshlrev_b32 v2, 16, v119
v_and_b32 v3, 0xffff0000, v119
v_add_f32 v122, v122, v2
v_fmac_f32 v123, v2, v2
v_add_f32 v122, v122, v3
v_mfma_f32_16x16x32_bf16 v[160:163], v[60:63], v[68:71], v[160:163]
v_fmac_f32 v123, v3, v3
v_lshlrev_b32 v2, 16, v120
v_and_b32 v3, 0xffff0000, v120
v_add_f32 v122, v122, v2
v_fmac_f32 v123, v2, v2
v_mfma_f32_16x16x32_bf16 v[152:155], v[56:59], v[76:79], v[152:155]
ds_read_b128 v[28:31], v10 offset:36864
v_add_f32 v122, v122, v3
v_fmac_f32 v123, v3, v3
s_nop 0
v_add_f32_dpp v122, v122, v122 row_shr:1 row_mask:0xf bank_mask:0xf bound_ctrl:0
v_add_f32_dpp v123, v123, v123 row_shr:1 row_mask:0xf bank_mask:0xf bound_ctrl:0
s_nop 0
v_add_f32_dpp v122, v122, v122 row_shr:2 row_mask:0xf bank_mask:0xf bound_ctrl:0
v_mfma_f32_16x16x32_bf16 v[164:167], v[60:63], v[72:75], v[164:167]
ds_read_b128 v[44:47], v14 offset:4096
v_add_f32_dpp v123, v123, v123 row_shr:2 row_mask:0xf bank_mask:0xf bound_ctrl:0
v_add_f32_dpp v122, v122, v122 row_shr:4 row_mask:0xf bank_mask:0xf bound_ctrl:0
s_nop 0
v_add_f32_dpp v123, v123, v123 row_shr:4 row_mask:0xf bank_mask:0xf bound_ctrl:0
v_add_f32_dpp v122, v122, v122 row_shr:8 row_mask:0xf bank_mask:0xf bound_ctrl:0
s_nop 0
v_add_f32_dpp v123, v123, v123 row_shr:8 row_mask:0xf bank_mask:0xf bound_ctrl:0
v_mfma_f32_16x16x32_bf16 v[168:171], v[60:63], v[76:79], v[168:171]
s_add_u32 m0, s49, 1024
s_add_u32 s52, s46, 768
buffer_load_dwordx4 v17, s[8:11], s52 offen lds
v_add_f32_dpp v122, v122, v122 row_bcast:15 row_mask:0xa bank_mask:0xf
v_add_f32_dpp v123, v123, v123 row_bcast:15 row_mask:0xa bank_mask:0xf
s_nop 0
v_add_f32_dpp v122, v122, v122 row_bcast:31 row_mask:0xc bank_mask:0xf
v_add_f32_dpp v123, v123, v123 row_bcast:31 row_mask:0xc bank_mask:0xf
v_mul_f32 v122, 0x3acccccd, v122
v_mfma_f32_16x16x32_bf16 v[140:143], v[52:55], v[80:83], v[140:143]
ds_read_b128 v[32:35], v10 offset:38912
v_mul_f32 v123, 0x3acccccd, v123
v_fma_f32 v123, -v122, v122, v123
v_max_f32 v123, 0, v123
v_cvt_pk_bf16_f32 v122, v122, v123
v_and_b32 v123, 0xffff0000, v122
v_mfma_f32_16x16x32_bf16 v[176:179], v[64:67], v[68:71], v[176:179]
ds_read_b128 v[48:51], v14 offset:5120
v_lshlrev_b32 v122, 16, v122
v_add_f32 v123, 0x3727c5ac, v123
v_cvt_pk_bf16_f32 v123, v123, v123
v_lshlrev_b32 v123, 16, v123
v_sqrt_f32 v123, v123
v_mfma_f32_16x16x32_bf16 v[156:159], v[56:59], v[80:83], v[156:159]
v_cvt_pk_bf16_f32 v123, v123, v123
v_lshlrev_b32 v123, 16, v123
v_rcp_f32 v123, v123
s_add_u32 s77, s77, 0
s_lshl_b64 exec, 1, 63
buffer_store_dwordx2 v[122:123], off, s[20:23], s77 sc1
s_mov_b64 exec, -1
v_mul_f32 v113, v98, v84
v_mfma_f32_16x16x32_bf16 v[180:183], v[64:67], v[72:75], v[180:183]
v_mul_f32 v115, v99, v84
v_fmac_f32 v113, v99, v85
v_fma_f32 v115, -v98, v85, v115
v_cvt_pk_bf16_f32 v104, v98, v113
v_cvt_pk_bf16_f32 v108, v99, v115
v_cndmask_b32 v108, v108, v103, s[78:79]
v_mfma_f32_16x16x32_bf16 v[172:175], v[60:63], v[80:83], v[172:175]
v_mul_f32 v112, v98, v86
v_mul_f32 v114, v99, v86
v_fmac_f32 v112, v99, v87
v_fma_f32 v114, -v98, v87, v114
v_mul_f32 v113, v98, v88
v_mfma_f32_16x16x32_bf16 v[184:187], v[64:67], v[76:79], v[184:187]
v_mul_f32 v115, v99, v88
v_fmac_f32 v113, v99, v89
v_fma_f32 v115, -v98, v89, v115
v_cvt_pk_bf16_f32 v105, v112, v113
v_cvt_pk_bf16_f32 v109, v114, v115
v_cndmask_b32 v109, v109, v103, s[78:79]
v_mfma_f32_16x16x32_bf16 v[188:191], v[64:67], v[80:83], v[188:191]
v_mul_f32 v112, v98, v90
v_mul_f32 v114, v99, v90
v_fmac_f32 v112, v99, v91
v_fma_f32 v114, -v98, v91, v114
v_mul_f32 v113, v98, v92
s_waitcnt lgkmcnt(0)
v_mfma_f32_16x16x32_bf16 v[192:195], v[20:23], v[36:39], 0
ds_read_b128 v[52:55], v11 offset:32768
s_add_u32 m0, s49, 2048
s_add_u32 s52, s47, 768
buffer_load_dwordx4 v16, s[8:11], s52 offen lds
v_mul_f32 v115, v99, v92
v_fmac_f32 v113, v99, v93
v_mfma_f32_16x16x32_bf16 v[196:199], v[20:23], v[40:43], 0
ds_read_b128 v[68:71], v14 offset:8192
v_fma_f32 v115, -v98, v93, v115
v_mfma_f32_16x16x32_bf16 v[208:211], v[24:27], v[36:39], 0
v_cvt_pk_bf16_f32 v106, v112, v113
v_cvt_pk_bf16_f32 v110, v114, v115
v_cndmask_b32 v110, v110, v103, s[78:79]
v_mfma_f32_16x16x32_bf16 v[212:215], v[24:27], v[40:43], 0
ds_read_b128 v[56:59], v11 offset:34816
v_mul_f32 v112, v98, v94
v_mfma_f32_16x16x32_bf16 v[200:203], v[20:23], v[44:47], 0
ds_read_b128 v[72:75], v14 offset:9216
v_mul_f32 v114, v99, v94
v_mfma_f32_16x16x32_bf16 v[224:227], v[28:31], v[36:39], 0
v_fmac_f32 v112, v99, v95
v_fma_f32 v114, -v98, v95, v114
v_mfma_f32_16x16x32_bf16 v[216:219], v[24:27], v[44:47], 0
ds_read_b128 v[60:63], v11 offset:36864
v_mul_f32 v113, v98, v96
v_mfma_f32_16x16x32_bf16 v[228:231], v[28:31], v[40:43], 0
ds_read_b128 v[76:79], v14 offset:12288
v_mul_f32 v115, v99, v96
v_mfma_f32_16x16x32_bf16 v[232:235], v[28:31], v[44:47], 0
s_add_u32 m0, s49, 3072
s_add_u32 s52, s48, 768
buffer_load_dwordx4 v17, s[8:11], s52 offen lds
v_fmac_f32 v113, v99, v97
v_fma_f32 v115, -v98, v97, v115
v_mfma_f32_16x16x32_bf16 v[204:207], v[20:23], v[48:51], 0
ds_read_b128 v[64:67], v11 offset:38912
v_cvt_pk_bf16_f32 v107, v112, v113
v_mfma_f32_16x16x32_bf16 v[240:243], v[32:35], v[36:39], 0
ds_read_b128 v[80:83], v14 offset:13312
v_cvt_pk_bf16_f32 v111, v114, v115
v_cndmask_b32 v111, v111, v103, s[78:79]
ds_write_b128 v102, v[104:107] offset:16384
v_mfma_f32_16x16x32_bf16 v[220:223], v[24:27], v[48:51], 0
ds_write_b128 v102, v[108:111] offset:20480
v_mfma_f32_16x16x32_bf16 v[244:247], v[32:35], v[40:43], 0
v_mul_f32 v112, v98, v100
v_mfma_f32_16x16x32_bf16 v[236:239], v[28:31], v[48:51], 0
v_mul_f32 v113, v99, v100
v_fmac_f32 v112, v99, v101
v_mfma_f32_16x16x32_bf16 v[248:251], v[32:35], v[44:47], 0
v_fma_f32 v99, -v98, v101, v113
v_mfma_f32_16x16x32_bf16 v[252:255], v[32:35], v[48:51], 0
v_mov_b32 v98, v112
s_waitcnt lgkmcnt(0)
s_waitcnt vmcnt(6)
s_barrier
v_mfma_f32_16x16x32_bf16 v[192:195], v[52:55], v[68:71], v[192:195]
ds_read_b128 v[20:23], v12 offset:0
s_add_u32 m0, s49, 32768
s_add_u32 s52, s45, 256
buffer_load_dwordx4 v16, s[8:11], s52 offen lds
v_mfma_f32_16x16x32_bf16 v[196:199], v[52:55], v[72:75], v[196:199]
ds_read_b128 v[36:39], v14 offset:16384
v_mfma_f32_16x16x32_bf16 v[208:211], v[56:59], v[68:71], v[208:211]
v_mfma_f32_16x16x32_bf16 v[212:215], v[56:59], v[72:75], v[212:215]
ds_read_b128 v[24:27], v12 offset:2048
v_mfma_f32_16x16x32_bf16 v[200:203], v[52:55], v[76:79], v[200:203]
ds_read_b128 v[40:43], v14 offset:17408
v_mfma_f32_16x16x32_bf16 v[224:227], v[60:63], v[68:71], v[224:227]
v_mfma_f32_16x16x32_bf16 v[216:219], v[56:59], v[76:79], v[216:219]
ds_read_b128 v[28:31], v12 offset:4096
v_mfma_f32_16x16x32_bf16 v[228:231], v[60:63], v[72:75], v[228:231]
ds_read_b128 v[44:47], v14 offset:20480
v_mfma_f32_16x16x32_bf16 v[232:235], v[60:63], v[76:79], v[232:235]
s_add_u32 m0, s49, 33792
s_add_u32 s52, s46, 256
buffer_load_dwordx4 v17, s[8:11], s52 offen lds
v_mfma_f32_16x16x32_bf16 v[204:207], v[52:55], v[80:83], v[204:207]
ds_read_b128 v[32:35], v12 offset:6144
v_mfma_f32_16x16x32_bf16 v[240:243], v[64:67], v[68:71], v[240:243]
ds_read_b128 v[48:51], v14 offset:21504
v_mfma_f32_16x16x32_bf16 v[220:223], v[56:59], v[80:83], v[220:223]
v_mfma_f32_16x16x32_bf16 v[244:247], v[64:67], v[72:75], v[244:247]
v_mfma_f32_16x16x32_bf16 v[236:239], v[60:63], v[80:83], v[236:239]
v_mfma_f32_16x16x32_bf16 v[248:251], v[64:67], v[76:79], v[248:251]
v_mfma_f32_16x16x32_bf16 v[252:255], v[64:67], v[80:83], v[252:255]
s_waitcnt lgkmcnt(0)
v_mfma_f32_16x16x32_bf16 v[128:131], v[20:23], v[36:39], v[128:131]
ds_read_b128 v[52:55], v13 offset:0
s_add_u32 m0, s49, 34816
s_add_u32 s52, s47, 256
buffer_load_dwordx4 v16, s[8:11], s52 offen lds
v_mfma_f32_16x16x32_bf16 v[132:135], v[20:23], v[40:43], v[132:135]
ds_read_b128 v[68:71], v14 offset:24576
v_mfma_f32_16x16x32_bf16 v[144:147], v[24:27], v[36:39], v[144:147]
v_mfma_f32_16x16x32_bf16 v[148:151], v[24:27], v[40:43], v[148:151]
ds_read_b128 v[56:59], v13 offset:2048
v_mfma_f32_16x16x32_bf16 v[136:139], v[20:23], v[44:47], v[136:139]
ds_read_b128 v[72:75], v14 offset:25600
v_mfma_f32_16x16x32_bf16 v[160:163], v[28:31], v[36:39], v[160:163]
v_mfma_f32_16x16x32_bf16 v[152:155], v[24:27], v[44:47], v[152:155]
ds_read_b128 v[60:63], v13 offset:4096
v_mfma_f32_16x16x32_bf16 v[164:167], v[28:31], v[40:43], v[164:167]
ds_read_b128 v[76:79], v14 offset:28672
v_mfma_f32_16x16x32_bf16 v[168:171], v[28:31], v[44:47], v[168:171]
s_add_u32 m0, s49, 35840
s_add_u32 s52, s48, 256
buffer_load_dwordx4 v17, s[8:11], s52 offen lds
v_mfma_f32_16x16x32_bf16 v[140:143], v[20:23], v[48:51], v[140:143]
ds_read_b128 v[64:67], v13 offset:6144
v_mfma_f32_16x16x32_bf16 v[176:179], v[32:35], v[36:39], v[176:179]
ds_read_b128 v[80:83], v14 offset:29696
v_mfma_f32_16x16x32_bf16 v[156:159], v[24:27], v[48:51], v[156:159]
v_mfma_f32_16x16x32_bf16 v[180:183], v[32:35], v[40:43], v[180:183]
v_mfma_f32_16x16x32_bf16 v[172:175], v[28:31], v[48:51], v[172:175]
v_mfma_f32_16x16x32_bf16 v[184:187], v[32:35], v[44:47], v[184:187]
v_mfma_f32_16x16x32_bf16 v[188:191], v[32:35], v[48:51], v[188:191]
s_waitcnt lgkmcnt(0)
s_waitcnt vmcnt(4)
s_barrier
v_mfma_f32_16x16x32_bf16 v[128:131], v[52:55], v[68:71], v[128:131]
ds_read_b128 v[20:23], v10 offset:0
s_add_u32 m0, s49, 65536
s_add_u32 s52, s45, 896
buffer_load_dwordx4 v16, s[8:11], s52 offen lds
v_mul_f32 v113, v98, v84
v_mul_f32 v115, v99, v84
v_mfma_f32_16x16x32_bf16 v[132:135], v[52:55], v[72:75], v[132:135]
ds_read_b128 v[36:39], v14 offset:16384
v_fmac_f32 v113, v99, v85
v_mfma_f32_16x16x32_bf16 v[144:147], v[56:59], v[68:71], v[144:147]
v_fma_f32 v115, -v98, v85, v115
v_mfma_f32_16x16x32_bf16 v[148:151], v[56:59], v[72:75], v[148:151]
ds_read_b128 v[24:27], v10 offset:2048
v_cvt_pk_bf16_f32 v104, v98, v113
v_cvt_pk_bf16_f32 v108, v99, v115
v_cndmask_b32 v108, v108, v103, s[78:79]
v_mfma_f32_16x16x32_bf16 v[136:139], v[52:55], v[76:79], v[136:139]
ds_read_b128 v[40:43], v14 offset:17408
v_mul_f32 v112, v98, v86
v_mfma_f32_16x16x32_bf16 v[160:163], v[60:63], v[68:71], v[160:163]
v_mul_f32 v114, v99, v86
v_mfma_f32_16x16x32_bf16 v[152:155], v[56:59], v[76:79], v[152:155]
ds_read_b128 v[28:31], v10 offset:4096
v_fmac_f32 v112, v99, v87
v_fma_f32 v114, -v98, v87, v114
v_mfma_f32_16x16x32_bf16 v[164:167], v[60:63], v[72:75], v[164:167]
ds_read_b128 v[44:47], v14 offset:20480
v_mul_f32 v113, v98, v88
v_mfma_f32_16x16x32_bf16 v[168:171], v[60:63], v[76:79], v[168:171]
s_add_u32 m0, s49, 66560
s_add_u32 s52, s46, 896
buffer_load_dwordx4 v17, s[8:11], s52 offen lds
v_mul_f32 v115, v99, v88
v_mfma_f32_16x16x32_bf16 v[140:143], v[52:55], v[80:83], v[140:143]
ds_read_b128 v[32:35], v10 offset:6144
v_fmac_f32 v113, v99, v89
v_fma_f32 v115, -v98, v89, v115
v_mfma_f32_16x16x32_bf16 v[176:179], v[64:67], v[68:71], v[176:179]
ds_read_b128 v[48:51], v14 offset:21504
v_cvt_pk_bf16_f32 v105, v112, v113
v_mfma_f32_16x16x32_bf16 v[156:159], v[56:59], v[80:83], v[156:159]
v_cvt_pk_bf16_f32 v109, v114, v115
v_cndmask_b32 v109, v109, v103, s[78:79]
v_mfma_f32_16x16x32_bf16 v[180:183], v[64:67], v[72:75], v[180:183]
v_mul_f32 v112, v98, v90
v_mul_f32 v114, v99, v90
v_mfma_f32_16x16x32_bf16 v[172:175], v[60:63], v[80:83], v[172:175]
v_fmac_f32 v112, v99, v91
v_mfma_f32_16x16x32_bf16 v[184:187], v[64:67], v[76:79], v[184:187]
v_fma_f32 v114, -v98, v91, v114
v_mfma_f32_16x16x32_bf16 v[188:191], v[64:67], v[80:83], v[188:191]
v_mul_f32 v113, v98, v92
s_waitcnt lgkmcnt(0)
v_mfma_f32_16x16x32_bf16 v[192:195], v[20:23], v[36:39], v[192:195]
ds_read_b128 v[52:55], v11 offset:0
s_add_u32 m0, s49, 67584
s_add_u32 s52, s47, 896
buffer_load_dwordx4 v16, s[8:11], s52 offen lds
v_mul_f32 v115, v99, v92
v_fmac_f32 v113, v99, v93
v_mfma_f32_16x16x32_bf16 v[196:199], v[20:23], v[40:43], v[196:199]
ds_read_b128 v[68:71], v14 offset:24576
v_fma_f32 v115, -v98, v93, v115
v_mfma_f32_16x16x32_bf16 v[208:211], v[24:27], v[36:39], v[208:211]
v_cvt_pk_bf16_f32 v106, v112, v113
v_cvt_pk_bf16_f32 v110, v114, v115
v_cndmask_b32 v110, v110, v103, s[78:79]
v_mfma_f32_16x16x32_bf16 v[212:215], v[24:27], v[40:43], v[212:215]
ds_read_b128 v[56:59], v11 offset:2048
v_mul_f32 v112, v98, v94
v_mfma_f32_16x16x32_bf16 v[200:203], v[20:23], v[44:47], v[200:203]
ds_read_b128 v[72:75], v14 offset:25600
v_mul_f32 v114, v99, v94
v_mfma_f32_16x16x32_bf16 v[224:227], v[28:31], v[36:39], v[224:227]
v_fmac_f32 v112, v99, v95
v_fma_f32 v114, -v98, v95, v114
v_mfma_f32_16x16x32_bf16 v[216:219], v[24:27], v[44:47], v[216:219]
ds_read_b128 v[60:63], v11 offset:4096
v_mul_f32 v113, v98, v96
v_mfma_f32_16x16x32_bf16 v[228:231], v[28:31], v[40:43], v[228:231]
ds_read_b128 v[76:79], v14 offset:28672
v_mul_f32 v115, v99, v96
v_mfma_f32_16x16x32_bf16 v[232:235], v[28:31], v[44:47], v[232:235]
s_add_u32 m0, s49, 68608
s_add_u32 s52, s48, 896
buffer_load_dwordx4 v17, s[8:11], s52 offen lds
v_fmac_f32 v113, v99, v97
v_fma_f32 v115, -v98, v97, v115
v_mfma_f32_16x16x32_bf16 v[204:207], v[20:23], v[48:51], v[204:207]
ds_read_b128 v[64:67], v11 offset:6144
v_cvt_pk_bf16_f32 v107, v112, v113
v_mfma_f32_16x16x32_bf16 v[240:243], v[32:35], v[36:39], v[240:243]
ds_read_b128 v[80:83], v14 offset:29696
v_cvt_pk_bf16_f32 v111, v114, v115
v_cndmask_b32 v111, v111, v103, s[78:79]
ds_write_b128 v102, v[104:107] offset:0
v_mfma_f32_16x16x32_bf16 v[220:223], v[24:27], v[48:51], v[220:223]
ds_write_b128 v102, v[108:111] offset:4096
v_mfma_f32_16x16x32_bf16 v[244:247], v[32:35], v[40:43], v[244:247]
v_mul_f32 v112, v98, v100
v_mfma_f32_16x16x32_bf16 v[236:239], v[28:31], v[48:51], v[236:239]
v_mul_f32 v113, v99, v100
v_fmac_f32 v112, v99, v101
v_mfma_f32_16x16x32_bf16 v[248:251], v[32:35], v[44:47], v[248:251]
v_fma_f32 v99, -v98, v101, v113
v_mfma_f32_16x16x32_bf16 v[252:255], v[32:35], v[48:51], v[252:255]
v_mov_b32 v98, v112
s_waitcnt lgkmcnt(0)
s_waitcnt vmcnt(4)
s_barrier
v_mfma_f32_16x16x32_bf16 v[192:195], v[52:55], v[68:71], v[192:195]
ds_read_b128 v[20:23], v10 offset:32768
s_add_u32 m0, s49, 0
s_add_u32 s52, s45, 384
buffer_load_dwordx4 v16, s[8:11], s52 offen lds
s_and_b32 s53, s2, 7
s_lshl_b32 s53, s53, 5
s_add_u32 s53, s53, s68
v_mov_b32 v126, 1
s_mov_b64 exec, 1
buffer_atomic_add v126, off, s[36:39], s53
s_mov_b64 exec, -1
v_mfma_f32_16x16x32_bf16 v[196:199], v[52:55], v[72:75], v[196:199]
ds_read_b128 v[36:39], v14 offset:0
v_mfma_f32_16x16x32_bf16 v[208:211], v[56:59], v[68:71], v[208:211]
v_mfma_f32_16x16x32_bf16 v[212:215], v[56:59], v[72:75], v[212:215]
ds_read_b128 v[24:27], v10 offset:34816
v_mfma_f32_16x16x32_bf16 v[200:203], v[52:55], v[76:79], v[200:203]
ds_read_b128 v[40:43], v14 offset:1024
v_mfma_f32_16x16x32_bf16 v[224:227], v[60:63], v[68:71], v[224:227]
v_mfma_f32_16x16x32_bf16 v[216:219], v[56:59], v[76:79], v[216:219]
ds_read_b128 v[28:31], v10 offset:36864
v_mfma_f32_16x16x32_bf16 v[228:231], v[60:63], v[72:75], v[228:231]
ds_read_b128 v[44:47], v14 offset:4096
v_mfma_f32_16x16x32_bf16 v[232:235], v[60:63], v[76:79], v[232:235]
s_add_u32 m0, s49, 1024
s_add_u32 s52, s46, 384
buffer_load_dwordx4 v17, s[8:11], s52 offen lds
v_mfma_f32_16x16x32_bf16 v[204:207], v[52:55], v[80:83], v[204:207]
ds_read_b128 v[32:35], v10 offset:38912
v_mfma_f32_16x16x32_bf16 v[240:243], v[64:67], v[68:71], v[240:243]
ds_read_b128 v[48:51], v14 offset:5120
v_mfma_f32_16x16x32_bf16 v[220:223], v[56:59], v[80:83], v[220:223]
v_mfma_f32_16x16x32_bf16 v[244:247], v[64:67], v[72:75], v[244:247]
v_mfma_f32_16x16x32_bf16 v[236:239], v[60:63], v[80:83], v[236:239]
v_mfma_f32_16x16x32_bf16 v[248:251], v[64:67], v[76:79], v[248:251]
v_mfma_f32_16x16x32_bf16 v[252:255], v[64:67], v[80:83], v[252:255]
s_waitcnt lgkmcnt(0)
v_mfma_f32_16x16x32_bf16 v[128:131], v[20:23], v[36:39], v[128:131]
ds_read_b128 v[52:55], v11 offset:32768
s_add_u32 m0, s49, 2048
s_add_u32 s52, s47, 384
buffer_load_dwordx4 v16, s[8:11], s52 offen lds
v_mfma_f32_16x16x32_bf16 v[132:135], v[20:23], v[40:43], v[132:135]
ds_read_b128 v[68:71], v14 offset:8192
v_mfma_f32_16x16x32_bf16 v[144:147], v[24:27], v[36:39], v[144:147]
v_mfma_f32_16x16x32_bf16 v[148:151], v[24:27], v[40:43], v[148:151]
ds_read_b128 v[56:59], v11 offset:34816
v_mfma_f32_16x16x32_bf16 v[136:139], v[20:23], v[44:47], v[136:139]
ds_read_b128 v[72:75], v14 offset:9216
v_mfma_f32_16x16x32_bf16 v[160:163], v[28:31], v[36:39], v[160:163]
v_mfma_f32_16x16x32_bf16 v[152:155], v[24:27], v[44:47], v[152:155]
ds_read_b128 v[60:63], v11 offset:36864
v_mfma_f32_16x16x32_bf16 v[164:167], v[28:31], v[40:43], v[164:167]
ds_read_b128 v[76:79], v14 offset:12288
v_mfma_f32_16x16x32_bf16 v[168:171], v[28:31], v[44:47], v[168:171]
s_add_u32 m0, s49, 3072
s_add_u32 s52, s48, 384
buffer_load_dwordx4 v17, s[8:11], s52 offen lds
v_mfma_f32_16x16x32_bf16 v[140:143], v[20:23], v[48:51], v[140:143]
ds_read_b128 v[64:67], v11 offset:38912
v_mfma_f32_16x16x32_bf16 v[176:179], v[32:35], v[36:39], v[176:179]
ds_read_b128 v[80:83], v14 offset:13312
v_mfma_f32_16x16x32_bf16 v[156:159], v[24:27], v[48:51], v[156:159]
v_mfma_f32_16x16x32_bf16 v[180:183], v[32:35], v[40:43], v[180:183]
v_mfma_f32_16x16x32_bf16 v[172:175], v[28:31], v[48:51], v[172:175]
v_mfma_f32_16x16x32_bf16 v[184:187], v[32:35], v[44:47], v[184:187]
v_mfma_f32_16x16x32_bf16 v[188:191], v[32:35], v[48:51], v[188:191]
s_waitcnt lgkmcnt(0)
s_waitcnt vmcnt(5)
s_barrier
v_mfma_f32_16x16x32_bf16 v[128:131], v[52:55], v[68:71], v[128:131]
ds_read_b128 v[20:23], v12 offset:0
s_add_u32 m0, s49, 32768
s_add_u32 s52, s45, 1024
buffer_load_dwordx4 v16, s[8:11], s52 offen lds
v_mul_f32 v113, v98, v84
v_mul_f32 v115, v99, v84
v_mfma_f32_16x16x32_bf16 v[132:135], v[52:55], v[72:75], v[132:135]
ds_read_b128 v[36:39], v14 offset:0
v_fmac_f32 v113, v99, v85
v_mfma_f32_16x16x32_bf16 v[144:147], v[56:59], v[68:71], v[144:147]
v_fma_f32 v115, -v98, v85, v115
v_mfma_f32_16x16x32_bf16 v[148:151], v[56:59], v[72:75], v[148:151]
ds_read_b128 v[24:27], v12 offset:2048
v_cvt_pk_bf16_f32 v104, v98, v113
v_cvt_pk_bf16_f32 v108, v99, v115
v_cndmask_b32 v108, v108, v103, s[78:79]
v_mfma_f32_16x16x32_bf16 v[136:139], v[52:55], v[76:79], v[136:139]
ds_read_b128 v[40:43], v14 offset:1024
v_mul_f32 v112, v98, v86
v_mfma_f32_16x16x32_bf16 v[160:163], v[60:63], v[68:71], v[160:163]
v_mul_f32 v114, v99, v86
v_mfma_f32_16x16x32_bf16 v[152:155], v[56:59], v[76:79], v[152:155]
ds_read_b128 v[28:31], v12 offset:4096
v_fmac_f32 v112, v99, v87
v_fma_f32 v114, -v98, v87, v114
v_mfma_f32_16x16x32_bf16 v[164:167], v[60:63], v[72:75], v[164:167]
ds_read_b128 v[44:47], v14 offset:4096
v_mul_f32 v113, v98, v88
v_mfma_f32_16x16x32_bf16 v[168:171], v[60:63], v[76:79], v[168:171]
s_add_u32 m0, s49, 33792
s_add_u32 s52, s46, 1024
buffer_load_dwordx4 v17, s[8:11], s52 offen lds
v_mul_f32 v115, v99, v88
v_mfma_f32_16x16x32_bf16 v[140:143], v[52:55], v[80:83], v[140:143]
ds_read_b128 v[32:35], v12 offset:6144
v_fmac_f32 v113, v99, v89
v_fma_f32 v115, -v98, v89, v115
v_mfma_f32_16x16x32_bf16 v[176:179], v[64:67], v[68:71], v[176:179]
ds_read_b128 v[48:51], v14 offset:5120
v_cvt_pk_bf16_f32 v105, v112, v113
v_mfma_f32_16x16x32_bf16 v[156:159], v[56:59], v[80:83], v[156:159]
v_cvt_pk_bf16_f32 v109, v114, v115
v_cndmask_b32 v109, v109, v103, s[78:79]
v_mfma_f32_16x16x32_bf16 v[180:183], v[64:67], v[72:75], v[180:183]
v_mul_f32 v112, v98, v90
v_mul_f32 v114, v99, v90
v_mfma_f32_16x16x32_bf16 v[172:175], v[60:63], v[80:83], v[172:175]
v_fmac_f32 v112, v99, v91
v_mfma_f32_16x16x32_bf16 v[184:187], v[64:67], v[76:79], v[184:187]
v_fma_f32 v114, -v98, v91, v114
v_mfma_f32_16x16x32_bf16 v[188:191], v[64:67], v[80:83], v[188:191]
v_mul_f32 v113, v98, v92
s_waitcnt lgkmcnt(0)
v_mfma_f32_16x16x32_bf16 v[192:195], v[20:23], v[36:39], v[192:195]
ds_read_b128 v[52:55], v13 offset:0
s_add_u32 m0, s49, 34816
s_add_u32 s52, s47, 1024
buffer_load_dwordx4 v16, s[8:11], s52 offen lds
v_mul_f32 v115, v99, v92
v_fmac_f32 v113, v99, v93
v_mfma_f32_16x16x32_bf16 v[196:199], v[20:23], v[40:43], v[196:199]
ds_read_b128 v[68:71], v14 offset:8192
v_fma_f32 v115, -v98, v93, v115
v_mfma_f32_16x16x32_bf16 v[208:211], v[24:27], v[36:39], v[208:211]
v_cvt_pk_bf16_f32 v106, v112, v113
v_cvt_pk_bf16_f32 v110, v114, v115
v_cndmask_b32 v110, v110, v103, s[78:79]
v_mfma_f32_16x16x32_bf16 v[212:215], v[24:27], v[40:43], v[212:215]
ds_read_b128 v[56:59], v13 offset:2048
v_mul_f32 v112, v98, v94
v_mfma_f32_16x16x32_bf16 v[200:203], v[20:23], v[44:47], v[200:203]
ds_read_b128 v[72:75], v14 offset:9216
v_mul_f32 v114, v99, v94
v_mfma_f32_16x16x32_bf16 v[224:227], v[28:31], v[36:39], v[224:227]
v_fmac_f32 v112, v99, v95
v_fma_f32 v114, -v98, v95, v114
v_mfma_f32_16x16x32_bf16 v[216:219], v[24:27], v[44:47], v[216:219]
ds_read_b128 v[60:63], v13 offset:4096
v_mul_f32 v113, v98, v96
v_mfma_f32_16x16x32_bf16 v[228:231], v[28:31], v[40:43], v[228:231]
ds_read_b128 v[76:79], v14 offset:12288
v_mul_f32 v115, v99, v96
v_mfma_f32_16x16x32_bf16 v[232:235], v[28:31], v[44:47], v[232:235]
s_add_u32 m0, s49, 35840
s_add_u32 s52, s48, 1024
buffer_load_dwordx4 v17, s[8:11], s52 offen lds
v_fmac_f32 v113, v99, v97
v_fma_f32 v115, -v98, v97, v115
v_mfma_f32_16x16x32_bf16 v[204:207], v[20:23], v[48:51], v[204:207]
ds_read_b128 v[64:67], v13 offset:6144
v_cvt_pk_bf16_f32 v107, v112, v113
v_mfma_f32_16x16x32_bf16 v[240:243], v[32:35], v[36:39], v[240:243]
ds_read_b128 v[80:83], v14 offset:13312
v_cvt_pk_bf16_f32 v111, v114, v115
v_cndmask_b32 v111, v111, v103, s[78:79]
ds_write_b128 v102, v[104:107] offset:16384
v_mfma_f32_16x16x32_bf16 v[220:223], v[24:27], v[48:51], v[220:223]
ds_write_b128 v102, v[108:111] offset:20480
v_mfma_f32_16x16x32_bf16 v[244:247], v[32:35], v[40:43], v[244:247]
v_mul_f32 v112, v98, v100
v_mfma_f32_16x16x32_bf16 v[236:239], v[28:31], v[48:51], v[236:239]
v_mul_f32 v113, v99, v100
v_fmac_f32 v112, v99, v101
v_mfma_f32_16x16x32_bf16 v[248:251], v[32:35], v[44:47], v[248:251]
v_fma_f32 v99, -v98, v101, v113
v_mfma_f32_16x16x32_bf16 v[252:255], v[32:35], v[48:51], v[252:255]
v_mov_b32 v98, v112
s_waitcnt lgkmcnt(0)
s_waitcnt vmcnt(4)
s_barrier
v_mfma_f32_16x16x32_bf16 v[192:195], v[52:55], v[68:71], v[192:195]
ds_read_b128 v[20:23], v10 offset:0
s_add_u32 m0, s49, 65536
s_add_u32 s52, s45, 512
buffer_load_dwordx4 v16, s[8:11], s52 offen lds
v_mfma_f32_16x16x32_bf16 v[196:199], v[52:55], v[72:75], v[196:199]
ds_read_b128 v[36:39], v14 offset:16384
v_mfma_f32_16x16x32_bf16 v[208:211], v[56:59], v[68:71], v[208:211]
v_mfma_f32_16x16x32_bf16 v[212:215], v[56:59], v[72:75], v[212:215]
ds_read_b128 v[24:27], v10 offset:2048
v_mfma_f32_16x16x32_bf16 v[200:203], v[52:55], v[76:79], v[200:203]
ds_read_b128 v[40:43], v14 offset:17408
v_mfma_f32_16x16x32_bf16 v[224:227], v[60:63], v[68:71], v[224:227]
v_mfma_f32_16x16x32_bf16 v[216:219], v[56:59], v[76:79], v[216:219]
ds_read_b128 v[28:31], v10 offset:4096
v_mfma_f32_16x16x32_bf16 v[228:231], v[60:63], v[72:75], v[228:231]
ds_read_b128 v[44:47], v14 offset:20480
v_mfma_f32_16x16x32_bf16 v[232:235], v[60:63], v[76:79], v[232:235]
s_add_u32 m0, s49, 66560
s_add_u32 s52, s46, 512
buffer_load_dwordx4 v17, s[8:11], s52 offen lds
v_mfma_f32_16x16x32_bf16 v[204:207], v[52:55], v[80:83], v[204:207]
ds_read_b128 v[32:35], v10 offset:6144
v_mfma_f32_16x16x32_bf16 v[240:243], v[64:67], v[68:71], v[240:243]
ds_read_b128 v[48:51], v14 offset:21504
v_mfma_f32_16x16x32_bf16 v[220:223], v[56:59], v[80:83], v[220:223]
v_mfma_f32_16x16x32_bf16 v[244:247], v[64:67], v[72:75], v[244:247]
v_mfma_f32_16x16x32_bf16 v[236:239], v[60:63], v[80:83], v[236:239]
v_mfma_f32_16x16x32_bf16 v[248:251], v[64:67], v[76:79], v[248:251]
v_mfma_f32_16x16x32_bf16 v[252:255], v[64:67], v[80:83], v[252:255]
s_waitcnt lgkmcnt(0)
v_mfma_f32_16x16x32_bf16 v[128:131], v[20:23], v[36:39], v[128:131]
ds_read_b128 v[52:55], v11 offset:0
s_add_u32 m0, s49, 67584
s_add_u32 s52, s47, 512
buffer_load_dwordx4 v16, s[8:11], s52 offen lds
v_mfma_f32_16x16x32_bf16 v[132:135], v[20:23], v[40:43], v[132:135]
ds_read_b128 v[68:71], v14 offset:24576
v_mfma_f32_16x16x32_bf16 v[144:147], v[24:27], v[36:39], v[144:147]
v_mfma_f32_16x16x32_bf16 v[148:151], v[24:27], v[40:43], v[148:151]
ds_read_b128 v[56:59], v11 offset:2048
v_mfma_f32_16x16x32_bf16 v[136:139], v[20:23], v[44:47], v[136:139]
ds_read_b128 v[72:75], v14 offset:25600
v_mfma_f32_16x16x32_bf16 v[160:163], v[28:31], v[36:39], v[160:163]
v_mfma_f32_16x16x32_bf16 v[152:155], v[24:27], v[44:47], v[152:155]
ds_read_b128 v[60:63], v11 offset:4096
v_mfma_f32_16x16x32_bf16 v[164:167], v[28:31], v[40:43], v[164:167]
ds_read_b128 v[76:79], v14 offset:28672
v_mfma_f32_16x16x32_bf16 v[168:171], v[28:31], v[44:47], v[168:171]
s_add_u32 m0, s49, 68608
s_add_u32 s52, s48, 512
buffer_load_dwordx4 v17, s[8:11], s52 offen lds
v_mfma_f32_16x16x32_bf16 v[140:143], v[20:23], v[48:51], v[140:143]
ds_read_b128 v[64:67], v11 offset:6144
v_mfma_f32_16x16x32_bf16 v[176:179], v[32:35], v[36:39], v[176:179]
ds_read_b128 v[80:83], v14 offset:29696
v_mfma_f32_16x16x32_bf16 v[156:159], v[24:27], v[48:51], v[156:159]
v_mfma_f32_16x16x32_bf16 v[180:183], v[32:35], v[40:43], v[180:183]
v_mfma_f32_16x16x32_bf16 v[172:175], v[28:31], v[48:51], v[172:175]
v_mfma_f32_16x16x32_bf16 v[184:187], v[32:35], v[44:47], v[184:187]
v_mfma_f32_16x16x32_bf16 v[188:191], v[32:35], v[48:51], v[188:191]
s_waitcnt lgkmcnt(0)
s_waitcnt vmcnt(4)
s_barrier
v_mfma_f32_16x16x32_bf16 v[128:131], v[52:55], v[68:71], v[128:131]
ds_read_b128 v[20:23], v10 offset:32768
s_add_u32 m0, s49, 0
s_add_u32 s52, s45, 1152
buffer_load_dwordx4 v16, s[8:11], s52 offen lds
v_mul_f32 v113, v98, v84
v_mul_f32 v115, v99, v84
v_mfma_f32_16x16x32_bf16 v[132:135], v[52:55], v[72:75], v[132:135]
ds_read_b128 v[36:39], v14 offset:16384
v_fmac_f32 v113, v99, v85
v_mfma_f32_16x16x32_bf16 v[144:147], v[56:59], v[68:71], v[144:147]
v_fma_f32 v115, -v98, v85, v115
v_mfma_f32_16x16x32_bf16 v[148:151], v[56:59], v[72:75], v[148:151]
ds_read_b128 v[24:27], v10 offset:34816
v_cvt_pk_bf16_f32 v104, v98, v113
v_mfma_f32_16x16x32_bf16 v[136:139], v[52:55], v[76:79], v[136:139]
ds_read_b128 v[40:43], v14 offset:17408
v_cvt_pk_bf16_f32 v108, v99, v115
v_cndmask_b32 v108, v108, v103, s[78:79]
v_mfma_f32_16x16x32_bf16 v[160:163], v[60:63], v[68:71], v[160:163]
v_mul_f32 v112, v98, v86
v_mul_f32 v114, v99, v86
v_mfma_f32_16x16x32_bf16 v[152:155], v[56:59], v[76:79], v[152:155]
ds_read_b128 v[28:31], v10 offset:36864
v_fmac_f32 v112, v99, v87
v_mfma_f32_16x16x32_bf16 v[164:167], v[60:63], v[72:75], v[164:167]
ds_read_b128 v[44:47], v14 offset:20480
v_fma_f32 v114, -v98, v87, v114
v_mfma_f32_16x16x32_bf16 v[168:171], v[60:63], v[76:79], v[168:171]
s_add_u32 m0, s49, 1024
s_add_u32 s52, s46, 1152
buffer_load_dwordx4 v17, s[8:11], s52 offen lds
v_mul_f32 v113, v98, v88
v_mfma_f32_16x16x32_bf16 v[140:143], v[52:55], v[80:83], v[140:143]
ds_read_b128 v[32:35], v10 offset:38912
v_mul_f32 v115, v99, v88
v_mfma_f32_16x16x32_bf16 v[176:179], v[64:67], v[68:71], v[176:179]
ds_read_b128 v[48:51], v14 offset:21504
v_fmac_f32 v113, v99, v89
v_fma_f32 v115, -v98, v89, v115
v_mfma_f32_16x16x32_bf16 v[156:159], v[56:59], v[80:83], v[156:159]
v_cvt_pk_bf16_f32 v105, v112, v113
v_mfma_f32_16x16x32_bf16 v[180:183], v[64:67], v[72:75], v[180:183]
v_cvt_pk_bf16_f32 v109, v114, v115
v_cndmask_b32 v109, v109, v103, s[78:79]
v_mfma_f32_16x16x32_bf16 v[172:175], v[60:63], v[80:83], v[172:175]
v_mul_f32 v112, v98, v90
v_mfma_f32_16x16x32_bf16 v[184:187], v[64:67], v[76:79], v[184:187]
v_mul_f32 v114, v99, v90
v_mfma_f32_16x16x32_bf16 v[188:191], v[64:67], v[80:83], v[188:191]
v_fmac_f32 v112, v99, v91
s_waitcnt lgkmcnt(0)
v_mfma_f32_16x16x32_bf16 v[192:195], v[20:23], v[36:39], v[192:195]
ds_read_b128 v[52:55], v11 offset:32768
s_add_u32 m0, s49, 2048
s_add_u32 s52, s47, 1152
buffer_load_dwordx4 v16, s[8:11], s52 offen lds
v_and_b32 v116, 7, v1
v_lshlrev_b32 v116, 5, v116
v_mfma_f32_16x16x32_bf16 v[196:199], v[20:23], v[40:43], v[196:199]
ds_read_b128 v[68:71], v14 offset:24576
buffer_load_dword v117, v116, s[36:39], s68 offen sc1
v_mfma_f32_16x16x32_bf16 v[208:211], v[24:27], v[36:39], v[208:211]
v_fma_f32 v114, -v98, v91, v114
v_mul_f32 v113, v98, v92
v_mfma_f32_16x16x32_bf16 v[212:215], v[24:27], v[40:43], v[212:215]
ds_read_b128 v[56:59], v11 offset:34816
v_mul_f32 v115, v99, v92
v_mfma_f32_16x16x32_bf16 v[200:203], v[20:23], v[44:47], v[200:203]
ds_read_b128 v[72:75], v14 offset:25600
v_fmac_f32 v113, v99, v93
v_mfma_f32_16x16x32_bf16 v[224:227], v[28:31], v[36:39], v[224:227]
v_fma_f32 v115, -v98, v93, v115
v_cvt_pk_bf16_f32 v106, v112, v113
v_mfma_f32_16x16x32_bf16 v[216:219], v[24:27], v[44:47], v[216:219]
ds_read_b128 v[60:63], v11 offset:36864
v_cvt_pk_bf16_f32 v110, v114, v115
v_cndmask_b32 v110, v110, v103, s[78:79]
v_mfma_f32_16x16x32_bf16 v[228:231], v[28:31], v[40:43], v[228:231]
ds_read_b128 v[76:79], v14 offset:28672
v_mul_f32 v112, v98, v94
v_mfma_f32_16x16x32_bf16 v[232:235], v[28:31], v[44:47], v[232:235]
s_add_u32 m0, s49, 3072
s_add_u32 s52, s48, 1152
buffer_load_dwordx4 v17, s[8:11], s52 offen lds
v_mul_f32 v114, v99, v94
v_fmac_f32 v112, v99, v95
v_mfma_f32_16x16x32_bf16 v[204:207], v[20:23], v[48:51], v[204:207]
ds_read_b128 v[64:67], v11 offset:38912
v_fma_f32 v114, -v98, v95, v114
v_mfma_f32_16x16x32_bf16 v[240:243], v[32:35], v[36:39], v[240:243]
ds_read_b128 v[80:83], v14 offset:29696
v_mul_f32 v113, v98, v96
v_mul_f32 v115, v99, v96
v_mfma_f32_16x16x32_bf16 v[220:223], v[24:27], v[48:51], v[220:223]
v_fmac_f32 v113, v99, v97
v_mfma_f32_16x16x32_bf16 v[244:247], v[32:35], v[40:43], v[244:247]
v_fma_f32 v115, -v98, v97, v115
v_mfma_f32_16x16x32_bf16 v[236:239], v[28:31], v[48:51], v[236:239]
v_cvt_pk_bf16_f32 v107, v112, v113
v_cvt_pk_bf16_f32 v111, v114, v115
v_cndmask_b32 v111, v111, v103, s[78:79]
v_mfma_f32_16x16x32_bf16 v[248:251], v[32:35], v[44:47], v[248:251]
ds_write_b128 v102, v[104:107] offset:0
v_mfma_f32_16x16x32_bf16 v[252:255], v[32:35], v[48:51], v[252:255]
ds_write_b128 v102, v[108:111] offset:4096
s_waitcnt lgkmcnt(0)
s_waitcnt vmcnt(5)
s_barrier
v_mfma_f32_16x16x32_bf16 v[192:195], v[52:55], v[68:71], v[192:195]
ds_read_b128 v[20:23], v12 offset:0
v_mfma_f32_16x16x32_bf16 v[196:199], v[52:55], v[72:75], v[196:199]
ds_read_b128 v[36:39], v14 offset:0
v_mfma_f32_16x16x32_bf16 v[208:211], v[56:59], v[68:71], v[208:211]
v_mfma_f32_16x16x32_bf16 v[212:215], v[56:59], v[72:75], v[212:215]
ds_read_b128 v[24:27], v12 offset:2048
v_mfma_f32_16x16x32_bf16 v[200:203], v[52:55], v[76:79], v[200:203]
ds_read_b128 v[40:43], v14 offset:1024
v_mfma_f32_16x16x32_bf16 v[224:227], v[60:63], v[68:71], v[224:227]
v_mfma_f32_16x16x32_bf16 v[216:219], v[56:59], v[76:79], v[216:219]
ds_read_b128 v[28:31], v12 offset:4096
v_mfma_f32_16x16x32_bf16 v[228:231], v[60:63], v[72:75], v[228:231]
ds_read_b128 v[44:47], v14 offset:4096
v_mfma_f32_16x16x32_bf16 v[232:235], v[60:63], v[76:79], v[232:235]
v_mfma_f32_16x16x32_bf16 v[204:207], v[52:55], v[80:83], v[204:207]
ds_read_b128 v[32:35], v12 offset:6144
v_mfma_f32_16x16x32_bf16 v[240:243], v[64:67], v[68:71], v[240:243]
ds_read_b128 v[48:51], v14 offset:5120
v_mfma_f32_16x16x32_bf16 v[220:223], v[56:59], v[80:83], v[220:223]
v_mfma_f32_16x16x32_bf16 v[244:247], v[64:67], v[72:75], v[244:247]
v_mfma_f32_16x16x32_bf16 v[236:239], v[60:63], v[80:83], v[236:239]
v_mfma_f32_16x16x32_bf16 v[248:251], v[64:67], v[76:79], v[248:251]
v_mfma_f32_16x16x32_bf16 v[252:255], v[64:67], v[80:83], v[252:255]
s_waitcnt lgkmcnt(0)
v_mfma_f32_16x16x32_bf16 v[128:131], v[20:23], v[36:39], v[128:131]
ds_read_b128 v[52:55], v13 offset:0
s_waitcnt vmcnt(1)
s_cmp_lg_u32 s40, 0
s_cbranch_scc1 K1_SPUN_D
v_cmp_ne_u32 vcc, 32, v117
s_cbranch_vccnz K1_SPIN_D
K1_SPUN_D:
v_mfma_f32_16x16x32_bf16 v[132:135], v[20:23], v[40:43], v[132:135]
ds_read_b128 v[68:71], v14 offset:8192
v_mfma_f32_16x16x32_bf16 v[144:147], v[24:27], v[36:39], v[144:147]
v_mfma_f32_16x16x32_bf16 v[148:151], v[24:27], v[40:43], v[148:151]
ds_read_b128 v[56:59], v13 offset:2048
v_mfma_f32_16x16x32_bf16 v[136:139], v[20:23], v[44:47], v[136:139]
ds_read_b128 v[72:75], v14 offset:9216
v_mfma_f32_16x16x32_bf16 v[160:163], v[28:31], v[36:39], v[160:163]
v_mfma_f32_16x16x32_bf16 v[152:155], v[24:27], v[44:47], v[152:155]
ds_read_b128 v[60:63], v13 offset:4096
v_mfma_f32_16x16x32_bf16 v[164:167], v[28:31], v[40:43], v[164:167]
ds_read_b128 v[76:79], v14 offset:12288
v_mfma_f32_16x16x32_bf16 v[168:171], v[28:31], v[44:47], v[168:171]
v_mfma_f32_16x16x32_bf16 v[140:143], v[20:23], v[48:51], v[140:143]
ds_read_b128 v[64:67], v13 offset:6144
v_mfma_f32_16x16x32_bf16 v[176:179], v[32:35], v[36:39], v[176:179]
ds_read_b128 v[80:83], v14 offset:13312
v_mfma_f32_16x16x32_bf16 v[156:159], v[24:27], v[48:51], v[156:159]
v_mfma_f32_16x16x32_bf16 v[180:183], v[32:35], v[40:43], v[180:183]
v_mfma_f32_16x16x32_bf16 v[172:175], v[28:31], v[48:51], v[172:175]
v_mfma_f32_16x16x32_bf16 v[184:187], v[32:35], v[44:47], v[184:187]
v_mfma_f32_16x16x32_bf16 v[188:191], v[32:35], v[48:51], v[188:191]
s_waitcnt lgkmcnt(0)
s_waitcnt vmcnt(0)
s_barrier
v_mfma_f32_16x16x32_bf16 v[128:131], v[52:55], v[68:71], v[128:131]
ds_read_b128 v[20:23], v10 offset:0
v_bfe_u32 v116, v1, 4, 1
v_mfma_f32_16x16x32_bf16 v[132:135], v[52:55], v[72:75], v[132:135]
ds_read_b128 v[36:39], v14 offset:0
v_lshlrev_b32 v116, 9, v116
v_mfma_f32_16x16x32_bf16 v[144:147], v[56:59], v[68:71], v[144:147]
v_and_b32 v118, 3, v1
v_mfma_f32_16x16x32_bf16 v[148:151], v[56:59], v[72:75], v[148:151]
ds_read_b128 v[24:27], v10 offset:2048
v_mfma_f32_16x16x32_bf16 v[136:139], v[52:55], v[76:79], v[136:139]
ds_read_b128 v[40:43], v14 offset:1024
v_lshl_add_u32 v116, v118, 6, v116
v_mfma_f32_16x16x32_bf16 v[160:163], v[60:63], v[68:71], v[160:163]
v_bfe_u32 v118, v1, 2, 2
v_mfma_f32_16x16x32_bf16 v[152:155], v[56:59], v[76:79], v[152:155]
ds_read_b128 v[28:31], v10 offset:4096
v_mfma_f32_16x16x32_bf16 v[164:167], v[60:63], v[72:75], v[164:167]
ds_read_b128 v[44:47], v14 offset:4096
v_add_u32 v116, v116, v118
v_mfma_f32_16x16x32_bf16 v[168:171], v[60:63], v[76:79], v[168:171]
s_mul_hi_u32 s53, s45, 0x333334
v_mfma_f32_16x16x32_bf16 v[140:143], v[52:55], v[80:83], v[140:143]
ds_read_b128 v[32:35], v10 offset:6144
v_mfma_f32_16x16x32_bf16 v[176:179], v[64:67], v[68:71], v[176:179]
ds_read_b128 v[48:51], v14 offset:5120
s_lshl_b32 s53, s53, 3
v_mfma_f32_16x16x32_bf16 v[156:159], v[56:59], v[80:83], v[156:159]
s_add_u32 s53, s53, 0
v_mfma_f32_16x16x32_bf16 v[180:183], v[64:67], v[72:75], v[180:183]
v_mfma_f32_16x16x32_bf16 v[172:175], v[60:63], v[80:83], v[172:175]
v_lshlrev_b32 v118, 3, v116
v_mfma_f32_16x16x32_bf16 v[184:187], v[64:67], v[76:79], v[184:187]
buffer_load_dwordx2 v[120:121], v118, s[20:23], s53 offen sc1
v_mfma_f32_16x16x32_bf16 v[188:191], v[64:67], v[80:83], v[188:191]
s_waitcnt lgkmcnt(0)
v_mfma_f32_16x16x32_bf16 v[192:195], v[20:23], v[36:39], v[192:195]
ds_read_b128 v[52:55], v11 offset:0
v_mfma_f32_16x16x32_bf16 v[196:199], v[20:23], v[40:43], v[196:199]
ds_read_b128 v[68:71], v14 offset:8192
v_mfma_f32_16x16x32_bf16 v[208:211], v[24:27], v[36:39], v[208:211]
v_mfma_f32_16x16x32_bf16 v[212:215], v[24:27], v[40:43], v[212:215]
ds_read_b128 v[56:59], v11 offset:2048
v_mfma_f32_16x16x32_bf16 v[200:203], v[20:23], v[44:47], v[200:203]
ds_read_b128 v[72:75], v14 offset:9216
v_mfma_f32_16x16x32_bf16 v[224:227], v[28:31], v[36:39], v[224:227]
v_mfma_f32_16x16x32_bf16 v[216:219], v[24:27], v[44:47], v[216:219]
ds_read_b128 v[60:63], v11 offset:4096
v_mfma_f32_16x16x32_bf16 v[228:231], v[28:31], v[40:43], v[228:231]
ds_read_b128 v[76:79], v14 offset:12288
v_mfma_f32_16x16x32_bf16 v[232:235], v[28:31], v[44:47], v[232:235]
v_mfma_f32_16x16x32_bf16 v[204:207], v[20:23], v[48:51], v[204:207]
ds_read_b128 v[64:67], v11 offset:6144
v_mfma_f32_16x16x32_bf16 v[240:243], v[32:35], v[36:39], v[240:243]
ds_read_b128 v[80:83], v14 offset:13312
v_mfma_f32_16x16x32_bf16 v[220:223], v[24:27], v[48:51], v[220:223]
v_mfma_f32_16x16x32_bf16 v[244:247], v[32:35], v[40:43], v[244:247]
v_mfma_f32_16x16x32_bf16 v[236:239], v[28:31], v[48:51], v[236:239]
v_mfma_f32_16x16x32_bf16 v[248:251], v[32:35], v[44:47], v[248:251]
v_mfma_f32_16x16x32_bf16 v[252:255], v[32:35], v[48:51], v[252:255]
s_waitcnt lgkmcnt(0)
s_barrier
v_mfma_f32_16x16x32_bf16 v[192:195], v[52:55], v[68:71], v[192:195]
v_mfma_f32_16x16x32_bf16 v[196:199], v[52:55], v[72:75], v[196:199]
v_mfma_f32_16x16x32_bf16 v[208:211], v[56:59], v[68:71], v[208:211]
v_mfma_f32_16x16x32_bf16 v[212:215], v[56:59], v[72:75], v[212:215]
v_mfma_f32_16x16x32_bf16 v[200:203], v[52:55], v[76:79], v[200:203]
v_mfma_f32_16x16x32_bf16 v[224:227], v[60:63], v[68:71], v[224:227]
v_mfma_f32_16x16x32_bf16 v[216:219], v[56:59], v[76:79], v[216:219]
v_mfma_f32_16x16x32_bf16 v[228:231], v[60:63], v[72:75], v[228:231]
v_mfma_f32_16x16x32_bf16 v[232:235], v[60:63], v[76:79], v[232:235]
v_mfma_f32_16x16x32_bf16 v[204:207], v[52:55], v[80:83], v[204:207]
v_mfma_f32_16x16x32_bf16 v[240:243], v[64:67], v[68:71], v[240:243]
v_mfma_f32_16x16x32_bf16 v[220:223], v[56:59], v[80:83], v[220:223]
v_mfma_f32_16x16x32_bf16 v[244:247], v[64:67], v[72:75], v[244:247]
v_mfma_f32_16x16x32_bf16 v[236:239], v[60:63], v[80:83], v[236:239]
v_mfma_f32_16x16x32_bf16 v[248:251], v[64:67], v[76:79], v[248:251]
v_mfma_f32_16x16x32_bf16 v[252:255], v[64:67], v[80:83], v[252:255]
s_waitcnt vmcnt(0)
v_and_b32 v118, 31, v1
s_lshl_b32 s53, s40, 7
s_add_u32 s53, s53, 147456
v_lshl_add_u32 v118, v118, 2, s53
ds_write_b32 v118, v121
s_waitcnt lgkmcnt(0)
s_barrier
v_and_b32 v2, 15, v1
v_lshrrev_b32 v3, 4, v1
s_lshl_b32 s53, s43, 8
s_add_u32 s53, s53, 147456
v_lshl_add_u32 v4, v3, 4, s53
ds_read_b128 v[20:23], v4 offset:0
ds_read_b128 v[24:27], v4 offset:64
ds_read_b128 v[28:31], v4 offset:128
ds_read_b128 v[32:35], v4 offset:192
v_and_b32 v5, 1, v1
v_lshlrev_b32 v5, 31, v5
v_or_b32 v52, 0x3f800000, v5
s_mul_i32 s53, s40, 9216
v_mul_u32_u24 v6, 144, v2
v_lshl_add_u32 v6, v3, 4, v6
v_add_u32 v6, s53, v6
v_lshrrev_b32 v7, 3, v1
v_and_b32 v8, 7, v1
v_mul_u32_u24 v9, 144, v7
v_lshl_add_u32 v9, v8, 4, v9
v_add_u32 v9, s53, v9
v_lshlrev_b32 v7, 13, v7
v_lshl_add_u32 v7, v8, 4, v7
s_waitcnt lgkmcnt(0)
v_pk_fma_f32 v[128:129], v[192:193], v[52:53], v[128:129] op_sel_hi:[1,0,1]
v_pk_mul_f32 v[128:129], v[128:129], v[20:21]
v_cvt_pk_bf16_f32 v56, v128, v129
v_pk_fma_f32 v[130:131], v[194:195], v[52:53], v[130:131] op_sel_hi:[1,0,1]
v_pk_mul_f32 v[130:131], v[130:131], v[22:23]
v_cvt_pk_bf16_f32 v57, v130, v131
v_pk_fma_f32 v[144:145], v[208:209], v[52:53], v[144:145] op_sel_hi:[1,0,1]
v_pk_mul_f32 v[144:145], v[144:145], v[24:25]
v_cvt_pk_bf16_f32 v58, v144, v145
v_pk_fma_f32 v[146:147], v[210:211], v[52:53], v[146:147] op_sel_hi:[1,0,1]
v_pk_mul_f32 v[146:147], v[146:147], v[26:27]
v_cvt_pk_bf16_f32 v59, v146, v147
ds_write_b128 v6, v[56:59] offset:0
v_pk_fma_f32 v[160:161], v[224:225], v[52:53], v[160:161] op_sel_hi:[1,0,1]
v_pk_mul_f32 v[160:161], v[160:161], v[28:29]
v_cvt_pk_bf16_f32 v60, v160, v161
v_pk_fma_f32 v[162:163], v[226:227], v[52:53], v[162:163] op_sel_hi:[1,0,1]
v_pk_mul_f32 v[162:163], v[162:163], v[30:31]
v_cvt_pk_bf16_f32 v61, v162, v163
v_pk_fma_f32 v[176:177], v[240:241], v[52:53], v[176:177] op_sel_hi:[1,0,1]
v_pk_mul_f32 v[176:177], v[176:177], v[32:33]
v_cvt_pk_bf16_f32 v62, v176, v177
v_pk_fma_f32 v[178:179], v[242:243], v[52:53], v[178:179] op_sel_hi:[1,0,1]
v_pk_mul_f32 v[178:179], v[178:179], v[34:35]
v_cvt_pk_bf16_f32 v63, v178, v179
ds_write_b128 v6, v[60:63] offset:64
v_pk_fma_f32 v[132:133], v[196:197], v[52:53], v[132:133] op_sel_hi:[1,0,1]
v_pk_mul_f32 v[132:133], v[132:133], v[20:21]
v_cvt_pk_bf16_f32 v64, v132, v133
v_pk_fma_f32 v[134:135], v[198:199], v[52:53], v[134:135] op_sel_hi:[1,0,1]
v_pk_mul_f32 v[134:135], v[134:135], v[22:23]
v_cvt_pk_bf16_f32 v65, v134, v135
v_pk_fma_f32 v[148:149], v[212:213], v[52:53], v[148:149] op_sel_hi:[1,0,1]
v_pk_mul_f32 v[148:149], v[148:149], v[24:25]
v_cvt_pk_bf16_f32 v66, v148, v149
v_pk_fma_f32 v[150:151], v[214:215], v[52:53], v[150:151] op_sel_hi:[1,0,1]
v_pk_mul_f32 v[150:151], v[150:151], v[26:27]
v_cvt_pk_bf16_f32 v67, v150, v151
ds_write_b128 v6, v[64:67] offset:2304
v_pk_fma_f32 v[164:165], v[228:229], v[52:53], v[164:165] op_sel_hi:[1,0,1]
v_pk_mul_f32 v[164:165], v[164:165], v[28:29]
v_cvt_pk_bf16_f32 v68, v164, v165
v_pk_fma_f32 v[166:167], v[230:231], v[52:53], v[166:167] op_sel_hi:[1,0,1]
v_pk_mul_f32 v[166:167], v[166:167], v[30:31]
v_cvt_pk_bf16_f32 v69, v166, v167
v_pk_fma_f32 v[180:181], v[244:245], v[52:53], v[180:181] op_sel_hi:[1,0,1]
v_pk_mul_f32 v[180:181], v[180:181], v[32:33]
v_cvt_pk_bf16_f32 v70, v180, v181
v_pk_fma_f32 v[182:183], v[246:247], v[52:53], v[182:183] op_sel_hi:[1,0,1]
v_pk_mul_f32 v[182:183], v[182:183], v[34:35]
v_cvt_pk_bf16_f32 v71, v182, v183
ds_write_b128 v6, v[68:71] offset:2368
v_pk_fma_f32 v[136:137], v[200:201], v[52:53], v[136:137] op_sel_hi:[1,0,1]
v_pk_mul_f32 v[136:137], v[136:137], v[20:21]
v_cvt_pk_bf16_f32 v56, v136, v137
v_pk_fma_f32 v[138:139], v[202:203], v[52:53], v[138:139] op_sel_hi:[1,0,1]
v_pk_mul_f32 v[138:139], v[138:139], v[22:23]
v_cvt_pk_bf16_f32 v57, v138, v139
v_pk_fma_f32 v[152:153], v[216:217], v[52:53], v[152:153] op_sel_hi:[1,0,1]
v_pk_mul_f32 v[152:153], v[152:153], v[24:25]
v_cvt_pk_bf16_f32 v58, v152, v153
v_pk_fma_f32 v[154:155], v[218:219], v[52:53], v[154:155] op_sel_hi:[1,0,1]
v_pk_mul_f32 v[154:155], v[154:155], v[26:27]
v_cvt_pk_bf16_f32 v59, v154, v155
ds_write_b128 v6, v[56:59] offset:4608
v_pk_fma_f32 v[168:169], v[232:233], v[52:53], v[168:169] op_sel_hi:[1,0,1]
v_pk_mul_f32 v[168:169], v[168:169], v[28:29]
v_cvt_pk_bf16_f32 v60, v168, v169
v_pk_fma_f32 v[170:171], v[234:235], v[52:53], v[170:171] op_sel_hi:[1,0,1]
v_pk_mul_f32 v[170:171], v[170:171], v[30:31]
v_cvt_pk_bf16_f32 v61, v170, v171
v_pk_fma_f32 v[184:185], v[248:249], v[52:53], v[184:185] op_sel_hi:[1,0,1]
v_pk_mul_f32 v[184:185], v[184:185], v[32:33]
v_cvt_pk_bf16_f32 v62, v184, v185
v_pk_fma_f32 v[186:187], v[250:251], v[52:53], v[186:187] op_sel_hi:[1,0,1]
v_pk_mul_f32 v[186:187], v[186:187], v[34:35]
v_cvt_pk_bf16_f32 v63, v186, v187
ds_write_b128 v6, v[60:63] offset:4672
v_pk_fma_f32 v[140:141], v[204:205], v[52:53], v[140:141] op_sel_hi:[1,0,1]
v_pk_mul_f32 v[140:141], v[140:141], v[20:21]
v_cvt_pk_bf16_f32 v64, v140, v141
v_pk_fma_f32 v[142:143], v[206:207], v[52:53], v[142:143] op_sel_hi:[1,0,1]
v_pk_mul_f32 v[142:143], v[142:143], v[22:23]
v_cvt_pk_bf16_f32 v65, v142, v143
v_pk_fma_f32 v[156:157], v[220:221], v[52:53], v[156:157] op_sel_hi:[1,0,1]
v_pk_mul_f32 v[156:157], v[156:157], v[24:25]
v_cvt_pk_bf16_f32 v66, v156, v157
v_pk_fma_f32 v[158:159], v[222:223], v[52:53], v[158:159] op_sel_hi:[1,0,1]
v_pk_mul_f32 v[158:159], v[158:159], v[26:27]
v_cvt_pk_bf16_f32 v67, v158, v159
ds_write_b128 v6, v[64:67] offset:6912
v_pk_fma_f32 v[172:173], v[236:237], v[52:53], v[172:173] op_sel_hi:[1,0,1]
v_pk_mul_f32 v[172:173], v[172:173], v[28:29]
v_cvt_pk_bf16_f32 v68, v172, v173
v_pk_fma_f32 v[174:175], v[238:239], v[52:53], v[174:175] op_sel_hi:[1,0,1]
v_pk_mul_f32 v[174:175], v[174:175], v[30:31]
v_cvt_pk_bf16_f32 v69, v174, v175
v_pk_fma_f32 v[188:189], v[252:253], v[52:53], v[188:189] op_sel_hi:[1,0,1]
v_pk_mul_f32 v[188:189], v[188:189], v[32:33]
v_cvt_pk_bf16_f32 v70, v188, v189
v_pk_fma_f32 v[190:191], v[254:255], v[52:53], v[190:191] op_sel_hi:[1,0,1]
v_pk_mul_f32 v[190:191], v[190:191], v[34:35]
v_cvt_pk_bf16_f32 v71, v190, v191
ds_write_b128 v6, v[68:71] offset:6976
s_sub_u32 s53, s42, 27
s_lshl_b32 s53, s53, 1
s_add_u32 s53, s53, s44
s_lshl_b32 s53, s53, 18
s_and_b32 s54, s41, 1
s_lshl_b32 s54, s54, 11
s_add_u32 s53, s53, s54
s_lshr_b32 s54, s41, 2
s_lshl_b32 s54, s54, 10
s_add_u32 s53, s53, s54
s_bfe_u32 s54, s41, 0x10001
s_lshl_b32 s54, s54, 9
s_add_u32 s53, s53, s54
s_lshl_b32 s54, s43, 7
s_add_u32 s53, s53, s54
s_add_u32 s53, s53, 9437184
s_waitcnt lgkmcnt(0)
ds_read_b128 v[72:75], v9 offset:0
ds_read_b128 v[76:79], v9 offset:1152
ds_read_b128 v[80:83], v9 offset:2304
ds_read_b128 v[84:87], v9 offset:3456
ds_read_b128 v[88:91], v9 offset:4608
ds_read_b128 v[92:95], v9 offset:5760
ds_read_b128 v[96:99], v9 offset:6912
ds_read_b128 v[100:103], v9 offset:8064
s_waitcnt lgkmcnt(7)
s_add_u32 s54, s53, 0
buffer_store_dwordx4 v[72:75], v7, s[20:23], s54 offen sc1
s_waitcnt lgkmcnt(6)
s_add_u32 s54, s53, 65536
buffer_store_dwordx4 v[76:79], v7, s[20:23], s54 offen sc1
s_waitcnt lgkmcnt(5)
s_add_u32 s54, s53, 131072
buffer_store_dwordx4 v[80:83], v7, s[20:23], s54 offen sc1
s_waitcnt lgkmcnt(4)
s_add_u32 s54, s53, 196608
buffer_store_dwordx4 v[84:87], v7, s[20:23], s54 offen sc1
s_waitcnt lgkmcnt(3)
s_add_u32 s54, s53, 4096
buffer_store_dwordx4 v[88:91], v7, s[20:23], s54 offen sc1
s_waitcnt lgkmcnt(2)
s_add_u32 s54, s53, 69632
buffer_store_dwordx4 v[92:95], v7, s[20:23], s54 offen sc1
s_waitcnt lgkmcnt(1)
s_add_u32 s54, s53, 135168
buffer_store_dwordx4 v[96:99], v7, s[20:23], s54 offen sc1
s_waitcnt lgkmcnt(0)
s_add_u32 s54, s53, 200704
buffer_store_dwordx4 v[100:103], v7, s[20:23], s54 offen sc1
s_branch PHASE2
K1_SPIN_D:
s_mov_b32 s53, 0
K1_SPINL_D:
s_sleep 8
buffer_load_dword v117, v116, s[36:39], 0 offen sc1
s_add_u32 s53, s53, 1
s_waitcnt vmcnt(0)
v_cmp_ne_u32 vcc, 32, v117
s_cmp_ge_u32 s53, 100000
s_cbranch_scc1 K1_SPUN_D
s_cbranch_vccz K1_SPUN_D
s_branch K1_SPINL_D
PHASE2:
s_barrier
s_and_b32 s3, s2, 7
s_lshr_b32 s4, s2, 3
s_and_b32 s5, s3, 3
s_lshl_b32 s5, s5, 3
s_and_b32 s6, s4, 7
s_add_u32 s70, s5, s6
s_lshr_b32 s5, s3, 2
s_lshl_b32 s5, s5, 2
s_lshr_b32 s6, s4, 3
s_add_u32 s71, s5, s6
v_lshlrev_b32 v2, 2, v1
v_and_b32 v2, 31, v2
v_add_u32 v2, 63488, v2
v_mov_b32 v3, 0
ds_write_b32 v2, v3
s_mov_b32 s16, s20
s_mov_b32 s17, s21
s_mov_b32 s18, s22
s_mov_b32 s19, s23
s_mov_b32 s28, s20
s_mov_b32 s29, s21
s_mov_b32 s30, s22
s_mov_b32 s31, s23
s_mov_b32 s12, s82
s_and_b32 s13, s83, 0xffff
s_mov_b32 s14, 2621440
s_mov_b32 s15, 0x20000
v_and_b32 v12, 31, v1
v_lshrrev_b32 v13, 5, v1
v_lshlrev_b32 v14, 4, v1
s_lshl_b32 s56, s40, 3
s_lshl_b32 s57, s40, 11
v_add_u32 v15, s57, v14
v_lshl_add_u32 v16, v13, 2, s56
v_add_u32 v17, 0, v16
v_mul_u32_u24 v17, v17, v12
v_cvt_f32_u32 v9, v17
v_mul_f32 v9, 0x3a000000, v9
v_cos_f32 v176, v9
v_sin_f32 v180, v9
v_add_u32 v17, 1, v16
v_mul_u32_u24 v17, v17, v12
v_cvt_f32_u32 v9, v17
v_mul_f32 v9, 0x3a000000, v9
v_cos_f32 v177, v9
v_sin_f32 v181, v9
v_add_u32 v17, 2, v16
v_mul_u32_u24 v17, v17, v12
v_cvt_f32_u32 v9, v17
v_mul_f32 v9, 0x3a000000, v9
v_cos_f32 v178, v9
v_sin_f32 v182, v9
v_add_u32 v17, 3, v16
v_mul_u32_u24 v17, v17, v12
v_cvt_f32_u32 v9, v17
v_mul_f32 v9, 0x3a000000, v9
v_cos_f32 v179, v9
v_sin_f32 v183, v9
ds_write_b128 v15, v[176:179] offset:0
ds_write_b128 v15, v[180:183] offset:1024
s_lshr_b32 s56, s40, 2
s_lshl_b32 s56, s56, 5
v_add_u32 v18, s56, v12
s_and_b32 s56, s40, 3
s_lshl_b32 s56, s56, 3
v_lshl_add_u32 v16, v13, 2, s56
v_add_u32 v17, 0, v16
v_mul_u32_u24 v17, v17, v18
v_cvt_f32_u32 v9, v17
v_mul_f32 v9, 0x3a000000, v9
v_cos_f32 v184, v9
v_sin_f32 v188, v9
v_add_u32 v17, 1, v16
v_mul_u32_u24 v17, v17, v18
v_cvt_f32_u32 v9, v17
v_mul_f32 v9, 0x3a000000, v9
v_cos_f32 v185, v9
v_sin_f32 v189, v9
v_add_u32 v17, 2, v16
v_mul_u32_u24 v17, v17, v18
v_cvt_f32_u32 v9, v17
v_mul_f32 v9, 0x3a000000, v9
v_cos_f32 v186, v9
v_sin_f32 v190, v9
v_add_u32 v17, 3, v16
v_mul_u32_u24 v17, v17, v18
v_cvt_f32_u32 v9, v17
v_mul_f32 v9, 0x3a000000, v9
v_cos_f32 v187, v9
v_sin_f32 v191, v9
v_mul_f32 v184, 0x354ccccd, v184
v_mul_f32 v185, 0x354ccccd, v185
v_mul_f32 v186, 0x354ccccd, v186
v_mul_f32 v187, 0x354ccccd, v187
v_mul_f32 v188, 0x354ccccd, v188
v_mul_f32 v189, 0x354ccccd, v189
v_mul_f32 v190, 0x354ccccd, v190
v_mul_f32 v191, 0x354ccccd, v191
ds_write_b128 v15, v[184:187] offset:16384
ds_write_b128 v15, v[188:191] offset:17408
s_and_b32 s56, s40, 3
s_lshl_b32 s56, s56, 4
v_lshl_add_u32 v16, v13, 2, s56
v_add_u32 v17, 0, v16
v_mul_u32_u24 v17, v17, v18
v_and_b32 v17, 63, v17
v_cvt_f32_u32 v9, v17
v_mul_f32 v9, 0x3c800000, v9
v_cos_f32 v192, v9
v_sin_f32 v200, v9
v_add_u32 v17, 1, v16
v_mul_u32_u24 v17, v17, v18
v_and_b32 v17, 63, v17
v_cvt_f32_u32 v9, v17
v_mul_f32 v9, 0x3c800000, v9
v_cos_f32 v193, v9
v_sin_f32 v201, v9
v_add_u32 v17, 2, v16
v_mul_u32_u24 v17, v17, v18
v_and_b32 v17, 63, v17
v_cvt_f32_u32 v9, v17
v_mul_f32 v9, 0x3c800000, v9
v_cos_f32 v194, v9
v_sin_f32 v202, v9
v_add_u32 v17, 3, v16
v_mul_u32_u24 v17, v17, v18
v_and_b32 v17, 63, v17
v_cvt_f32_u32 v9, v17
v_mul_f32 v9, 0x3c800000, v9
v_cos_f32 v195, v9
v_sin_f32 v203, v9
v_add_u32 v17, 8, v16
v_mul_u32_u24 v17, v17, v18
v_and_b32 v17, 63, v17
v_cvt_f32_u32 v9, v17
v_mul_f32 v9, 0x3c800000, v9
v_cos_f32 v196, v9
v_sin_f32 v204, v9
v_add_u32 v17, 9, v16
v_mul_u32_u24 v17, v17, v18
v_and_b32 v17, 63, v17
v_cvt_f32_u32 v9, v17
v_mul_f32 v9, 0x3c800000, v9
v_cos_f32 v197, v9
v_sin_f32 v205, v9
v_add_u32 v17, 10, v16
v_mul_u32_u24 v17, v17, v18
v_and_b32 v17, 63, v17
v_cvt_f32_u32 v9, v17
v_mul_f32 v9, 0x3c800000, v9
v_cos_f32 v198, v9
v_sin_f32 v206, v9
v_add_u32 v17, 11, v16
v_mul_u32_u24 v17, v17, v18
v_and_b32 v17, 63, v17
v_cvt_f32_u32 v9, v17
v_mul_f32 v9, 0x3c800000, v9
v_cos_f32 v199, v9
v_sin_f32 v207, v9
v_cvt_pk_bf16_f32 v208, v192, v193
v_cvt_pk_bf16_f32 v216, v200, v201
v_xor_b32 v212, 0x80008000, v216
v_cvt_pk_bf16_f32 v209, v194, v195
v_cvt_pk_bf16_f32 v217, v202, v203
v_xor_b32 v213, 0x80008000, v217
v_cvt_pk_bf16_f32 v210, v196, v197
v_cvt_pk_bf16_f32 v218, v204, v205
v_xor_b32 v214, 0x80008000, v218
v_cvt_pk_bf16_f32 v211, v198, v199
v_cvt_pk_bf16_f32 v219, v206, v207
v_xor_b32 v215, 0x80008000, v219
s_lshl_b32 s57, s40, 10
s_add_u32 s57, s57, 32768
v_add_u32 v15, s57, v14
ds_write_b128 v15, v[208:211]
ds_write_b128 v15, v[212:215] offset:8192
ds_write_b128 v15, v[216:219] offset:16384
s_cmp_lt_u32 s40, 6
s_cbranch_scc1 K2_NOF32
s_sub_u32 s55, s40, 6
s_lshl_b32 s56, s55, 4
v_lshl_add_u32 v16, v13, 2, s56
v_mov_b32 v18, v12
v_add_u32 v17, 0, v16
v_mul_u32_u24 v17, v17, v18
v_and_b32 v17, 31, v17
v_cvt_f32_u32 v9, v17
v_mul_f32 v9, 0x3d000000, v9
v_cos_f32 v192, v9
v_sin_f32 v200, v9
v_add_u32 v17, 1, v16
v_mul_u32_u24 v17, v17, v18
v_and_b32 v17, 31, v17
v_cvt_f32_u32 v9, v17
v_mul_f32 v9, 0x3d000000, v9
v_cos_f32 v193, v9
v_sin_f32 v201, v9
v_add_u32 v17, 2, v16
v_mul_u32_u24 v17, v17, v18
v_and_b32 v17, 31, v17
v_cvt_f32_u32 v9, v17
v_mul_f32 v9, 0x3d000000, v9
v_cos_f32 v194, v9
v_sin_f32 v202, v9
v_add_u32 v17, 3, v16
v_mul_u32_u24 v17, v17, v18
v_and_b32 v17, 31, v17
v_cvt_f32_u32 v9, v17
v_mul_f32 v9, 0x3d000000, v9
v_cos_f32 v195, v9
v_sin_f32 v203, v9
v_add_u32 v17, 8, v16
v_mul_u32_u24 v17, v17, v18
v_and_b32 v17, 31, v17
v_cvt_f32_u32 v9, v17
v_mul_f32 v9, 0x3d000000, v9
v_cos_f32 v196, v9
v_sin_f32 v204, v9
v_add_u32 v17, 9, v16
v_mul_u32_u24 v17, v17, v18
v_and_b32 v17, 31, v17
v_cvt_f32_u32 v9, v17
v_mul_f32 v9, 0x3d000000, v9
v_cos_f32 v197, v9
v_sin_f32 v205, v9
v_add_u32 v17, 10, v16
v_mul_u32_u24 v17, v17, v18
v_and_b32 v17, 31, v17
v_cvt_f32_u32 v9, v17
v_mul_f32 v9, 0x3d000000, v9
v_cos_f32 v198, v9
v_sin_f32 v206, v9
v_add_u32 v17, 11, v16
v_mul_u32_u24 v17, v17, v18
v_and_b32 v17, 31, v17
v_cvt_f32_u32 v9, v17
v_mul_f32 v9, 0x3d000000, v9
v_cos_f32 v199, v9
v_sin_f32 v207, v9
v_cvt_pk_bf16_f32 v208, v192, v193
v_cvt_pk_bf16_f32 v216, v200, v201
v_xor_b32 v212, 0x80008000, v216
v_cvt_pk_bf16_f32 v209, v194, v195
v_cvt_pk_bf16_f32 v217, v202, v203
v_xor_b32 v213, 0x80008000, v217
v_cvt_pk_bf16_f32 v210, v196, v197
v_cvt_pk_bf16_f32 v218, v204, v205
v_xor_b32 v214, 0x80008000, v218
v_cvt_pk_bf16_f32 v211, v198, v199
v_cvt_pk_bf16_f32 v219, v206, v207
v_xor_b32 v215, 0x80008000, v219
s_lshl_b32 s57, s55, 10
s_add_u32 s57, s57, 57344
v_add_u32 v15, s57, v14
ds_write_b128 v15, v[208:211]
ds_write_b128 v15, v[212:215] offset:2048
ds_write_b128 v15, v[216:219] offset:4096
K2_NOF32:
s_waitcnt vmcnt(0) lgkmcnt(0)
s_barrier
s_cmp_ge_u32 s42, 27
s_cbranch_scc1 P2_ARRD
s_lshl_b32 s55, s41, 7
s_add_u32 s55, s55, s68
s_add_u32 s55, s55, 303104
v_mov_b32 v5, 1
v_lshlrev_b32 v6, 10, v1
s_mov_b64 exec, 0xff
buffer_atomic_add v5, v6, s[16:19], s55 offen
s_mov_b64 exec, -1
s_branch P2_ARRX
P2_ARRD:
s_add_u32 s55, s68, 311296
v_mov_b32 v5, 1
v_lshlrev_b32 v6, 7, v1
s_mov_b64 exec, 0xff
buffer_atomic_add v5, v6, s[16:19], s55 offen
s_mov_b64 exec, -1
P2_ARRX:
s_cmp_ge_u32 s40, 4
s_cbranch_scc1 K2_COL
v_lshlrev_b32 v2, 4, v1
s_mul_i32 s54, s40, 14
s_cmp_eq_u32 s40, 3
s_cselect_b32 s55, 1, 0
s_sub_u32 s54, s54, s55
s_lshl_b32 s55, s70, 2
s_mul_i32 s55, s55, 54
s_add_u32 s55, s55, s54
s_lshl_b32 s55, s55, 10
s_add_u32 s44, s55, 1048576
s_add_u32 s45, s44, 55296
s_add_u32 s46, s44, 110592
s_add_u32 s47, s44, 165888
s_mul_i32 s55, s71, 370
s_add_u32 s55, s55, s54
s_lshl_b32 s55, s55, 10
s_add_u32 s48, s55, 15728640
s_add_u32 s49, s48, 75776
s_add_u32 s50, s48, 151552
s_add_u32 s51, s48, 227328
s_add_u32 s52, s48, 303104
s_cmp_lg_u32 s40, 0
s_cbranch_scc1 P2_GW1
v_and_b32 v3, 7, v1
v_lshlrev_b32 v3, 7, v3
v_mov_b32 v4, 27
s_and_b32 s57, s2, 7
s_lshl_b32 s57, s57, 10
s_add_u32 s43, s57, 294912
s_mov_b32 s55, 0
P2_PWD:
buffer_load_dword v5, v3, s[16:19], s43 offen sc1
s_add_u32 s55, s55, 1
s_waitcnt vmcnt(0)
v_cmp_ne_u32 vcc, v4, v5
s_cmp_ge_u32 s55, 100000
s_cbranch_scc1 P2_PWDD
s_cbranch_vccz P2_PWDD
s_sleep 3
s_branch P2_PWD
P2_PWDD:
v_mov_b32 v5, 63504
v_mov_b32 v6, 1
ds_write_b32 v5, v6
s_branch P2_GW2
P2_GW1:
v_mov_b32 v5, 63504
s_mov_b32 s55, 0
P2_LWD:
ds_read_b32 v6, v5
s_add_u32 s55, s55, 1
s_waitcnt lgkmcnt(0)
v_readfirstlane_b32 s56, v6
s_cmp_ge_u32 s55, 2000000
s_cbranch_scc1 P2_LWDD
s_cmp_lg_u32 s56, 0
s_cbranch_scc1 P2_LWDD
s_sleep 1
s_branch P2_LWD
P2_LWDD:
P2_GW2:
buffer_load_dwordx4 v[36:39], v2, s[20:23], s48 offen offset:0
buffer_load_dwordx4 v[40:43], v2, s[20:23], s49 offen offset:0
buffer_load_dwordx4 v[44:47], v2, s[20:23], s50 offen offset:0
buffer_load_dwordx4 v[48:51], v2, s[20:23], s51 offen offset:0
buffer_load_dwordx4 v[52:55], v2, s[20:23], s52 offen offset:0
buffer_load_dwordx4 v[72:75], v2, s[20:23], s48 offen offset:1024
buffer_load_dwordx4 v[76:79], v2, s[20:23], s49 offen offset:1024
buffer_load_dwordx4 v[80:83], v2, s[20:23], s50 offen offset:1024
buffer_load_dwordx4 v[84:87], v2, s[20:23], s51 offen offset:1024
buffer_load_dwordx4 v[88:91], v2, s[20:23], s52 offen offset:1024
buffer_load_dwordx4 v[108:111], v2, s[20:23], s48 offen offset:2048
buffer_load_dwordx4 v[112:115], v2, s[20:23], s49 offen offset:2048
buffer_load_dwordx4 v[116:119], v2, s[20:23], s50 offen offset:2048
buffer_load_dwordx4 v[120:123], v2, s[20:23], s51 offen offset:2048
buffer_load_dwordx4 v[124:127], v2, s[20:23], s52 offen offset:2048
s_cmp_lg_u32 s40, 0
s_cbranch_scc1 P2_GW3
s_lshr_b32 s57, s70, 2
s_lshl_b32 s57, s57, 7
s_and_b32 s43, s2, 7
s_lshl_b32 s43, s43, 10
s_add_u32 s43, s43, s57
s_add_u32 s43, s43, 303104
v_mov_b32 v3, 0
v_mov_b32 v4, 27
s_mov_b32 s55, 0
P2_PH:
buffer_load_dword v5, v3, s[16:19], s43 offen sc1
s_add_u32 s55, s55, 1
s_waitcnt vmcnt(0)
v_cmp_ne_u32 vcc, v4, v5
s_cmp_ge_u32 s55, 100000
s_cbranch_scc1 P2_PHD
s_cbranch_vccz P2_PHD
s_sleep 3
s_branch P2_PH
P2_PHD:
v_mov_b32 v5, 63508
v_mov_b32 v6, 1
ds_write_b32 v5, v6
s_branch P2_GW4
P2_GW3:
v_mov_b32 v5, 63508
s_mov_b32 s55, 0
P2_LH:
ds_read_b32 v6, v5
s_add_u32 s55, s55, 1
s_waitcnt lgkmcnt(0)
v_readfirstlane_b32 s56, v6
s_cmp_ge_u32 s55, 2000000
s_cbranch_scc1 P2_LHD
s_cmp_lg_u32 s56, 0
s_cbranch_scc1 P2_LHD
s_sleep 1
s_branch P2_LH
P2_LHD:
P2_GW4:
buffer_load_dwordx4 v[20:23], v2, s[20:23], s44 offen offset:0
buffer_load_dwordx4 v[24:27], v2, s[20:23], s45 offen offset:0
buffer_load_dwordx4 v[28:31], v2, s[20:23], s46 offen offset:0
buffer_load_dwordx4 v[32:35], v2, s[20:23], s47 offen offset:0
buffer_load_dwordx4 v[56:59], v2, s[20:23], s44 offen offset:1024
buffer_load_dwordx4 v[60:63], v2, s[20:23], s45 offen offset:1024
buffer_load_dwordx4 v[64:67], v2, s[20:23], s46 offen offset:1024
buffer_load_dwordx4 v[68:71], v2, s[20:23], s47 offen offset:1024
buffer_load_dwordx4 v[92:95], v2, s[20:23], s44 offen offset:2048
buffer_load_dwordx4 v[96:99], v2, s[20:23], s45 offen offset:2048
buffer_load_dwordx4 v[100:103], v2, s[20:23], s46 offen offset:2048
buffer_load_dwordx4 v[104:107], v2, s[20:23], s47 offen offset:2048
s_add_u32 s20, s20, 3072
s_addc_u32 s21, s21, 0
s_waitcnt vmcnt(8)
v_mfma_f32_16x16x32_bf16 v[176:179], v[36:39], v[20:23], 0
buffer_load_dwordx4 v[128:131], v2, s[20:23], s44 offen
v_mfma_f32_16x16x32_bf16 v[180:183], v[40:43], v[20:23], 0
v_mfma_f32_16x16x32_bf16 v[184:187], v[44:47], v[20:23], 0
buffer_load_dwordx4 v[144:147], v2, s[20:23], s48 offen
v_mfma_f32_16x16x32_bf16 v[188:191], v[48:51], v[20:23], 0
v_mfma_f32_16x16x32_bf16 v[192:195], v[52:55], v[20:23], 0
buffer_load_dwordx4 v[132:135], v2, s[20:23], s45 offen
v_mfma_f32_16x16x32_bf16 v[196:199], v[36:39], v[24:27], 0
v_mfma_f32_16x16x32_bf16 v[200:203], v[40:43], v[24:27], 0
buffer_load_dwordx4 v[148:151], v2, s[20:23], s49 offen
v_mfma_f32_16x16x32_bf16 v[204:207], v[44:47], v[24:27], 0
v_mfma_f32_16x16x32_bf16 v[208:211], v[48:51], v[24:27], 0
buffer_load_dwordx4 v[136:139], v2, s[20:23], s46 offen
v_mfma_f32_16x16x32_bf16 v[212:215], v[52:55], v[24:27], 0
v_mfma_f32_16x16x32_bf16 v[216:219], v[36:39], v[28:31], 0
buffer_load_dwordx4 v[152:155], v2, s[20:23], s50 offen
v_mfma_f32_16x16x32_bf16 v[220:223], v[40:43], v[28:31], 0
v_mfma_f32_16x16x32_bf16 v[224:227], v[44:47], v[28:31], 0
buffer_load_dwordx4 v[140:143], v2, s[20:23], s47 offen
v_mfma_f32_16x16x32_bf16 v[228:231], v[48:51], v[28:31], 0
v_mfma_f32_16x16x32_bf16 v[232:235], v[52:55], v[28:31], 0
buffer_load_dwordx4 v[156:159], v2, s[20:23], s51 offen
v_mfma_f32_16x16x32_bf16 v[236:239], v[36:39], v[32:35], 0
v_mfma_f32_16x16x32_bf16 v[240:243], v[40:43], v[32:35], 0
buffer_load_dwordx4 v[160:163], v2, s[20:23], s52 offen
v_mfma_f32_16x16x32_bf16 v[244:247], v[44:47], v[32:35], 0
v_mfma_f32_16x16x32_bf16 v[248:251], v[48:51], v[32:35], 0
s_add_u32 s20, s20, 1024
s_addc_u32 s21, s21, 0
v_mfma_f32_16x16x32_bf16 v[252:255], v[52:55], v[32:35], 0
s_waitcnt vmcnt(13)
v_mfma_f32_16x16x32_bf16 v[176:179], v[72:75], v[56:59], v[176:179]
buffer_load_dwordx4 v[20:23], v2, s[20:23], s44 offen
v_mfma_f32_16x16x32_bf16 v[180:183], v[76:79], v[56:59], v[180:183]
v_mfma_f32_16x16x32_bf16 v[184:187], v[80:83], v[56:59], v[184:187]
buffer_load_dwordx4 v[36:39], v2, s[20:23], s48 offen
v_mfma_f32_16x16x32_bf16 v[188:191], v[84:87], v[56:59], v[188:191]
v_mfma_f32_16x16x32_bf16 v[192:195], v[88:91], v[56:59], v[192:195]
buffer_load_dwordx4 v[24:27], v2, s[20:23], s45 offen
v_mfma_f32_16x16x32_bf16 v[196:199], v[72:75], v[60:63], v[196:199]
v_mfma_f32_16x16x32_bf16 v[200:203], v[76:79], v[60:63], v[200:203]
buffer_load_dwordx4 v[40:43], v2, s[20:23], s49 offen
v_mfma_f32_16x16x32_bf16 v[204:207], v[80:83], v[60:63], v[204:207]
v_mfma_f32_16x16x32_bf16 v[208:211], v[84:87], v[60:63], v[208:211]
buffer_load_dwordx4 v[28:31], v2, s[20:23], s46 offen
v_mfma_f32_16x16x32_bf16 v[212:215], v[88:91], v[60:63], v[212:215]
v_mfma_f32_16x16x32_bf16 v[216:219], v[72:75], v[64:67], v[216:219]
buffer_load_dwordx4 v[44:47], v2, s[20:23], s50 offen
v_mfma_f32_16x16x32_bf16 v[220:223], v[76:79], v[64:67], v[220:223]
v_mfma_f32_16x16x32_bf16 v[224:227], v[80:83], v[64:67], v[224:227]
buffer_load_dwordx4 v[32:35], v2, s[20:23], s47 offen
v_mfma_f32_16x16x32_bf16 v[228:231], v[84:87], v[64:67], v[228:231]
v_mfma_f32_16x16x32_bf16 v[232:235], v[88:91], v[64:67], v[232:235]
buffer_load_dwordx4 v[48:51], v2, s[20:23], s51 offen
v_mfma_f32_16x16x32_bf16 v[236:239], v[72:75], v[68:71], v[236:239]
v_mfma_f32_16x16x32_bf16 v[240:243], v[76:79], v[68:71], v[240:243]
buffer_load_dwordx4 v[52:55], v2, s[20:23], s52 offen
v_mfma_f32_16x16x32_bf16 v[244:247], v[80:83], v[68:71], v[244:247]
v_mfma_f32_16x16x32_bf16 v[248:251], v[84:87], v[68:71], v[248:251]
s_add_u32 s20, s20, 1024
s_addc_u32 s21, s21, 0
v_mfma_f32_16x16x32_bf16 v[252:255], v[88:91], v[68:71], v[252:255]
s_waitcnt vmcnt(18)
v_mfma_f32_16x16x32_bf16 v[176:179], v[108:111], v[92:95], v[176:179]
buffer_load_dwordx4 v[56:59], v2, s[20:23], s44 offen
v_mfma_f32_16x16x32_bf16 v[180:183], v[112:115], v[92:95], v[180:183]
v_mfma_f32_16x16x32_bf16 v[184:187], v[116:119], v[92:95], v[184:187]
buffer_load_dwordx4 v[72:75], v2, s[20:23], s48 offen
v_mfma_f32_16x16x32_bf16 v[188:191], v[120:123], v[92:95], v[188:191]
v_mfma_f32_16x16x32_bf16 v[192:195], v[124:127], v[92:95], v[192:195]
buffer_load_dwordx4 v[60:63], v2, s[20:23], s45 offen
v_mfma_f32_16x16x32_bf16 v[196:199], v[108:111], v[96:99], v[196:199]
v_mfma_f32_16x16x32_bf16 v[200:203], v[112:115], v[96:99], v[200:203]
buffer_load_dwordx4 v[76:79], v2, s[20:23], s49 offen
v_mfma_f32_16x16x32_bf16 v[204:207], v[116:119], v[96:99], v[204:207]
v_mfma_f32_16x16x32_bf16 v[208:211], v[120:123], v[96:99], v[208:211]
buffer_load_dwordx4 v[64:67], v2, s[20:23], s46 offen
v_mfma_f32_16x16x32_bf16 v[212:215], v[124:127], v[96:99], v[212:215]
v_mfma_f32_16x16x32_bf16 v[216:219], v[108:111], v[100:103], v[216:219]
buffer_load_dwordx4 v[80:83], v2, s[20:23], s50 offen
v_mfma_f32_16x16x32_bf16 v[220:223], v[112:115], v[100:103], v[220:223]
v_mfma_f32_16x16x32_bf16 v[224:227], v[116:119], v[100:103], v[224:227]
buffer_load_dwordx4 v[68:71], v2, s[20:23], s47 offen
v_mfma_f32_16x16x32_bf16 v[228:231], v[120:123], v[100:103], v[228:231]
v_mfma_f32_16x16x32_bf16 v[232:235], v[124:127], v[100:103], v[232:235]
buffer_load_dwordx4 v[84:87], v2, s[20:23], s51 offen
v_mfma_f32_16x16x32_bf16 v[236:239], v[108:111], v[104:107], v[236:239]
v_mfma_f32_16x16x32_bf16 v[240:243], v[112:115], v[104:107], v[240:243]
buffer_load_dwordx4 v[88:91], v2, s[20:23], s52 offen
v_mfma_f32_16x16x32_bf16 v[244:247], v[116:119], v[104:107], v[244:247]
v_mfma_f32_16x16x32_bf16 v[248:251], v[120:123], v[104:107], v[248:251]
s_add_u32 s20, s20, 1024
s_addc_u32 s21, s21, 0
v_mfma_f32_16x16x32_bf16 v[252:255], v[124:127], v[104:107], v[252:255]
s_waitcnt vmcnt(18)
v_mfma_f32_16x16x32_bf16 v[176:179], v[144:147], v[128:131], v[176:179]
buffer_load_dwordx4 v[92:95], v2, s[20:23], s44 offen
v_mfma_f32_16x16x32_bf16 v[180:183], v[148:151], v[128:131], v[180:183]
v_mfma_f32_16x16x32_bf16 v[184:187], v[152:155], v[128:131], v[184:187]
buffer_load_dwordx4 v[108:111], v2, s[20:23], s48 offen
v_mfma_f32_16x16x32_bf16 v[188:191], v[156:159], v[128:131], v[188:191]
v_mfma_f32_16x16x32_bf16 v[192:195], v[160:163], v[128:131], v[192:195]
buffer_load_dwordx4 v[96:99], v2, s[20:23], s45 offen
v_mfma_f32_16x16x32_bf16 v[196:199], v[144:147], v[132:135], v[196:199]
v_mfma_f32_16x16x32_bf16 v[200:203], v[148:151], v[132:135], v[200:203]
buffer_load_dwordx4 v[112:115], v2, s[20:23], s49 offen
v_mfma_f32_16x16x32_bf16 v[204:207], v[152:155], v[132:135], v[204:207]
v_mfma_f32_16x16x32_bf16 v[208:211], v[156:159], v[132:135], v[208:211]
buffer_load_dwordx4 v[100:103], v2, s[20:23], s46 offen
v_mfma_f32_16x16x32_bf16 v[212:215], v[160:163], v[132:135], v[212:215]
v_mfma_f32_16x16x32_bf16 v[216:219], v[144:147], v[136:139], v[216:219]
buffer_load_dwordx4 v[116:119], v2, s[20:23], s50 offen
v_mfma_f32_16x16x32_bf16 v[220:223], v[148:151], v[136:139], v[220:223]
v_mfma_f32_16x16x32_bf16 v[224:227], v[152:155], v[136:139], v[224:227]
buffer_load_dwordx4 v[104:107], v2, s[20:23], s47 offen
v_mfma_f32_16x16x32_bf16 v[228:231], v[156:159], v[136:139], v[228:231]
v_mfma_f32_16x16x32_bf16 v[232:235], v[160:163], v[136:139], v[232:235]
buffer_load_dwordx4 v[120:123], v2, s[20:23], s51 offen
v_mfma_f32_16x16x32_bf16 v[236:239], v[144:147], v[140:143], v[236:239]
v_mfma_f32_16x16x32_bf16 v[240:243], v[148:151], v[140:143], v[240:243]
buffer_load_dwordx4 v[124:127], v2, s[20:23], s52 offen
v_mfma_f32_16x16x32_bf16 v[244:247], v[152:155], v[140:143], v[244:247]
v_mfma_f32_16x16x32_bf16 v[248:251], v[156:159], v[140:143], v[248:251]
s_add_u32 s20, s20, 1024
s_addc_u32 s21, s21, 0
v_mfma_f32_16x16x32_bf16 v[252:255], v[160:163], v[140:143], v[252:255]
s_waitcnt vmcnt(18)
v_mfma_f32_16x16x32_bf16 v[176:179], v[36:39], v[20:23], v[176:179]
buffer_load_dwordx4 v[128:131], v2, s[20:23], s44 offen
v_mfma_f32_16x16x32_bf16 v[180:183], v[40:43], v[20:23], v[180:183]
v_mfma_f32_16x16x32_bf16 v[184:187], v[44:47], v[20:23], v[184:187]
buffer_load_dwordx4 v[144:147], v2, s[20:23], s48 offen
v_mfma_f32_16x16x32_bf16 v[188:191], v[48:51], v[20:23], v[188:191]
v_mfma_f32_16x16x32_bf16 v[192:195], v[52:55], v[20:23], v[192:195]
buffer_load_dwordx4 v[132:135], v2, s[20:23], s45 offen
v_mfma_f32_16x16x32_bf16 v[196:199], v[36:39], v[24:27], v[196:199]
v_mfma_f32_16x16x32_bf16 v[200:203], v[40:43], v[24:27], v[200:203]
buffer_load_dwordx4 v[148:151], v2, s[20:23], s49 offen
v_mfma_f32_16x16x32_bf16 v[204:207], v[44:47], v[24:27], v[204:207]
v_mfma_f32_16x16x32_bf16 v[208:211], v[48:51], v[24:27], v[208:211]
buffer_load_dwordx4 v[136:139], v2, s[20:23], s46 offen
v_mfma_f32_16x16x32_bf16 v[212:215], v[52:55], v[24:27], v[212:215]
v_mfma_f32_16x16x32_bf16 v[216:219], v[36:39], v[28:31], v[216:219]
buffer_load_dwordx4 v[152:155], v2, s[20:23], s50 offen
v_mfma_f32_16x16x32_bf16 v[220:223], v[40:43], v[28:31], v[220:223]
v_mfma_f32_16x16x32_bf16 v[224:227], v[44:47], v[28:31], v[224:227]
buffer_load_dwordx4 v[140:143], v2, s[20:23], s47 offen
v_mfma_f32_16x16x32_bf16 v[228:231], v[48:51], v[28:31], v[228:231]
v_mfma_f32_16x16x32_bf16 v[232:235], v[52:55], v[28:31], v[232:235]
buffer_load_dwordx4 v[156:159], v2, s[20:23], s51 offen
v_mfma_f32_16x16x32_bf16 v[236:239], v[36:39], v[32:35], v[236:239]
v_mfma_f32_16x16x32_bf16 v[240:243], v[40:43], v[32:35], v[240:243]
buffer_load_dwordx4 v[160:163], v2, s[20:23], s52 offen
v_mfma_f32_16x16x32_bf16 v[244:247], v[44:47], v[32:35], v[244:247]
v_mfma_f32_16x16x32_bf16 v[248:251], v[48:51], v[32:35], v[248:251]
s_add_u32 s20, s20, 1024
s_addc_u32 s21, s21, 0
v_mfma_f32_16x16x32_bf16 v[252:255], v[52:55], v[32:35], v[252:255]
s_waitcnt vmcnt(18)
v_mfma_f32_16x16x32_bf16 v[176:179], v[72:75], v[56:59], v[176:179]
buffer_load_dwordx4 v[20:23], v2, s[20:23], s44 offen
s_lshl_b32 s56, s40, 4
v_add_u32 v6, 0, v1
v_mul_u32_u24 v7, 3277, v6
v_mfma_f32_16x16x32_bf16 v[180:183], v[76:79], v[56:59], v[180:183]
v_lshrrev_b32 v7, 16, v7
v_mul_u32_u24 v8, 20, v7
v_sub_u32 v8, v6, v8
v_mfma_f32_16x16x32_bf16 v[184:187], v[80:83], v[56:59], v[184:187]
buffer_load_dwordx4 v[36:39], v2, s[20:23], s48 offen
v_add_u32 v7, s56, v7
v_mul_u32_u24 v9, 336, v7
v_lshl_add_u32 v9, v8, 4, v9
v_mfma_f32_16x16x32_bf16 v[188:191], v[84:87], v[56:59], v[188:191]
v_add_u32 v164, 63616, v9
v_mul_u32_u24 v9, 1280, v7
v_lshl_add_u32 v169, v8, 3, v9
v_mfma_f32_16x16x32_bf16 v[192:195], v[88:91], v[56:59], v[192:195]
buffer_load_dwordx4 v[24:27], v2, s[20:23], s45 offen
v_add_u32 v6, 64, v1
v_mul_u32_u24 v7, 3277, v6
v_lshrrev_b32 v7, 16, v7
v_mfma_f32_16x16x32_bf16 v[196:199], v[72:75], v[60:63], v[196:199]
v_mul_u32_u24 v8, 20, v7
v_sub_u32 v8, v6, v8
v_add_u32 v7, s56, v7
v_mfma_f32_16x16x32_bf16 v[200:203], v[76:79], v[60:63], v[200:203]
buffer_load_dwordx4 v[40:43], v2, s[20:23], s49 offen
v_mul_u32_u24 v9, 336, v7
v_lshl_add_u32 v9, v8, 4, v9
v_add_u32 v165, 63616, v9
v_mfma_f32_16x16x32_bf16 v[204:207], v[80:83], v[60:63], v[204:207]
v_mul_u32_u24 v9, 1280, v7
v_lshl_add_u32 v170, v8, 3, v9
v_add_u32 v6, 128, v1
v_mfma_f32_16x16x32_bf16 v[208:211], v[84:87], v[60:63], v[208:211]
buffer_load_dwordx4 v[28:31], v2, s[20:23], s46 offen
v_mul_u32_u24 v7, 3277, v6
v_lshrrev_b32 v7, 16, v7
v_mul_u32_u24 v8, 20, v7
v_mfma_f32_16x16x32_bf16 v[212:215], v[88:91], v[60:63], v[212:215]
v_sub_u32 v8, v6, v8
v_add_u32 v7, s56, v7
v_mul_u32_u24 v9, 336, v7
v_mfma_f32_16x16x32_bf16 v[216:219], v[72:75], v[64:67], v[216:219]
buffer_load_dwordx4 v[44:47], v2, s[20:23], s50 offen
v_lshl_add_u32 v9, v8, 4, v9
v_add_u32 v166, 63616, v9
v_mul_u32_u24 v9, 1280, v7
v_mfma_f32_16x16x32_bf16 v[220:223], v[76:79], v[64:67], v[220:223]
v_lshl_add_u32 v171, v8, 3, v9
v_add_u32 v6, 192, v1
v_mul_u32_u24 v7, 3277, v6
v_mfma_f32_16x16x32_bf16 v[224:227], v[80:83], v[64:67], v[224:227]
buffer_load_dwordx4 v[32:35], v2, s[20:23], s47 offen
v_lshrrev_b32 v7, 16, v7
v_mul_u32_u24 v8, 20, v7
v_sub_u32 v8, v6, v8
v_mfma_f32_16x16x32_bf16 v[228:231], v[84:87], v[64:67], v[228:231]
v_add_u32 v7, s56, v7
v_mul_u32_u24 v9, 336, v7
v_lshl_add_u32 v9, v8, 4, v9
v_mfma_f32_16x16x32_bf16 v[232:235], v[88:91], v[64:67], v[232:235]
buffer_load_dwordx4 v[48:51], v2, s[20:23], s51 offen
v_add_u32 v167, 63616, v9
v_mul_u32_u24 v9, 1280, v7
v_lshl_add_u32 v172, v8, 3, v9
v_mfma_f32_16x16x32_bf16 v[236:239], v[72:75], v[68:71], v[236:239]
v_add_u32 v6, 256, v1
v_mul_u32_u24 v7, 3277, v6
v_lshrrev_b32 v7, 16, v7
v_mfma_f32_16x16x32_bf16 v[240:243], v[76:79], v[68:71], v[240:243]
buffer_load_dwordx4 v[52:55], v2, s[20:23], s52 offen
v_mul_u32_u24 v8, 20, v7
v_sub_u32 v8, v6, v8
v_add_u32 v7, s56, v7
v_mfma_f32_16x16x32_bf16 v[244:247], v[80:83], v[68:71], v[244:247]
v_mul_u32_u24 v9, 336, v7
v_lshl_add_u32 v9, v8, 4, v9
v_add_u32 v168, 63616, v9
v_mfma_f32_16x16x32_bf16 v[248:251], v[84:87], v[68:71], v[248:251]
s_add_u32 s20, s20, 1024
s_addc_u32 s21, s21, 0
v_mul_u32_u24 v9, 1280, v7
v_lshl_add_u32 v173, v8, 3, v9
s_lshl_b32 s56, s70, 6
v_mfma_f32_16x16x32_bf16 v[252:255], v[88:91], v[68:71], v[252:255]
s_mul_i32 s56, s56, 1280
s_mul_i32 s57, s71, 160
s_add_u32 s58, s56, s57
s_waitcnt vmcnt(18)
v_mfma_f32_16x16x32_bf16 v[176:179], v[108:111], v[92:95], v[176:179]
buffer_load_dwordx4 v[56:59], v2, s[20:23], s44 offen
v_mfma_f32_16x16x32_bf16 v[180:183], v[112:115], v[92:95], v[180:183]
v_mfma_f32_16x16x32_bf16 v[184:187], v[116:119], v[92:95], v[184:187]
buffer_load_dwordx4 v[72:75], v2, s[20:23], s48 offen
v_mfma_f32_16x16x32_bf16 v[188:191], v[120:123], v[92:95], v[188:191]
v_mfma_f32_16x16x32_bf16 v[192:195], v[124:127], v[92:95], v[192:195]
buffer_load_dwordx4 v[60:63], v2, s[20:23], s45 offen
v_mfma_f32_16x16x32_bf16 v[196:199], v[108:111], v[96:99], v[196:199]
v_mfma_f32_16x16x32_bf16 v[200:203], v[112:115], v[96:99], v[200:203]
buffer_load_dwordx4 v[76:79], v2, s[20:23], s49 offen
v_mfma_f32_16x16x32_bf16 v[204:207], v[116:119], v[96:99], v[204:207]
v_mfma_f32_16x16x32_bf16 v[208:211], v[120:123], v[96:99], v[208:211]
buffer_load_dwordx4 v[64:67], v2, s[20:23], s46 offen
v_mfma_f32_16x16x32_bf16 v[212:215], v[124:127], v[96:99], v[212:215]
v_mfma_f32_16x16x32_bf16 v[216:219], v[108:111], v[100:103], v[216:219]
buffer_load_dwordx4 v[80:83], v2, s[20:23], s50 offen
v_mfma_f32_16x16x32_bf16 v[220:223], v[112:115], v[100:103], v[220:223]
v_mfma_f32_16x16x32_bf16 v[224:227], v[116:119], v[100:103], v[224:227]
buffer_load_dwordx4 v[68:71], v2, s[20:23], s47 offen
v_mfma_f32_16x16x32_bf16 v[228:231], v[120:123], v[100:103], v[228:231]
v_mfma_f32_16x16x32_bf16 v[232:235], v[124:127], v[100:103], v[232:235]
buffer_load_dwordx4 v[84:87], v2, s[20:23], s51 offen
v_mfma_f32_16x16x32_bf16 v[236:239], v[108:111], v[104:107], v[236:239]
v_mfma_f32_16x16x32_bf16 v[240:243], v[112:115], v[104:107], v[240:243]
buffer_load_dwordx4 v[88:91], v2, s[20:23], s52 offen
v_mfma_f32_16x16x32_bf16 v[244:247], v[116:119], v[104:107], v[244:247]
v_mfma_f32_16x16x32_bf16 v[248:251], v[120:123], v[104:107], v[248:251]
s_add_u32 s20, s20, 1024
s_addc_u32 s21, s21, 0
v_mfma_f32_16x16x32_bf16 v[252:255], v[124:127], v[104:107], v[252:255]
s_waitcnt vmcnt(18)
v_mfma_f32_16x16x32_bf16 v[176:179], v[144:147], v[128:131], v[176:179]
buffer_load_dwordx4 v[92:95], v2, s[20:23], s44 offen
v_lshrrev_b32 v6, 3, v1
v_lshlrev_b32 v6, 12, v6
v_mfma_f32_16x16x32_bf16 v[180:183], v[148:151], v[128:131], v[180:183]
v_bfe_u32 v7, v1, 4, 1
v_mfma_f32_16x16x32_bf16 v[184:187], v[152:155], v[128:131], v[184:187]
buffer_load_dwordx4 v[108:111], v2, s[20:23], s48 offen
v_lshlrev_b32 v7, 1, v7
v_and_b32 v8, 7, v1
v_mfma_f32_16x16x32_bf16 v[188:191], v[156:159], v[128:131], v[188:191]
v_xor_b32 v7, v7, v8
v_mfma_f32_16x16x32_bf16 v[192:195], v[160:163], v[128:131], v[192:195]
buffer_load_dwordx4 v[96:99], v2, s[20:23], s45 offen
v_lshl_add_u32 v16, v7, 4, v6
v_xor_b32 v17, 64, v16
v_mfma_f32_16x16x32_bf16 v[196:199], v[144:147], v[132:135], v[196:199]
s_mul_i32 s53, s40, 655360
v_mfma_f32_16x16x32_bf16 v[200:203], v[148:151], v[132:135], v[200:203]
buffer_load_dwordx4 v[112:115], v2, s[20:23], s49 offen
s_lshl_b32 s57, s70, 7
s_add_u32 s53, s53, s57
v_mfma_f32_16x16x32_bf16 v[204:207], v[152:155], v[132:135], v[204:207]
s_add_u32 s53, s53, 19922944
v_mfma_f32_16x16x32_bf16 v[208:211], v[156:159], v[132:135], v[208:211]
buffer_load_dwordx4 v[100:103], v2, s[20:23], s46 offen
s_mul_i32 s59, s40, 21504
s_add_u32 s59, s59, 63616
v_mfma_f32_16x16x32_bf16 v[212:215], v[160:163], v[132:135], v[212:215]
v_and_b32 v8, 15, v1
v_mfma_f32_16x16x32_bf16 v[216:219], v[144:147], v[136:139], v[216:219]
buffer_load_dwordx4 v[116:119], v2, s[20:23], s50 offen
v_lshrrev_b32 v9, 4, v1
v_mfma_f32_16x16x32_bf16 v[220:223], v[148:151], v[136:139], v[220:223]
v_lshrrev_b32 v10, 2, v8
v_lshl_add_u32 v10, v9, 3, v10
v_mfma_f32_16x16x32_bf16 v[224:227], v[152:155], v[136:139], v[224:227]
buffer_load_dwordx4 v[104:107], v2, s[20:23], s47 offen
v_bfe_u32 v11, v1, 3, 1
v_mfma_f32_16x16x32_bf16 v[228:231], v[156:159], v[136:139], v[228:231]
v_and_b32 v12, 1, v9
v_lshl_or_b32 v11, v12, 1, v11
v_mfma_f32_16x16x32_bf16 v[232:235], v[160:163], v[136:139], v[232:235]
buffer_load_dwordx4 v[120:123], v2, s[20:23], s51 offen
v_lshlrev_b32 v11, 5, v11
v_mfma_f32_16x16x32_bf16 v[236:239], v[144:147], v[140:143], v[236:239]
v_lshl_add_u32 v10, v10, 7, v11
v_and_b32 v12, 3, v8
v_mfma_f32_16x16x32_bf16 v[240:243], v[148:151], v[140:143], v[240:243]
buffer_load_dwordx4 v[124:127], v2, s[20:23], s52 offen
v_lshl_add_u32 v10, v12, 3, v10
v_mfma_f32_16x16x32_bf16 v[244:247], v[152:155], v[140:143], v[244:247]
v_add_u32 v12, s59, v10
v_xor_b32 v13, 32, v12
v_mfma_f32_16x16x32_bf16 v[248:251], v[156:159], v[140:143], v[248:251]
s_add_u32 s20, s20, 1024
s_addc_u32 s21, s21, 0
v_xor_b32 v14, 64, v12
v_mfma_f32_16x16x32_bf16 v[252:255], v[160:163], v[140:143], v[252:255]
v_xor_b32 v15, 96, v12
s_waitcnt vmcnt(18)
v_mfma_f32_16x16x32_bf16 v[176:179], v[36:39], v[20:23], v[176:179]
buffer_load_dwordx4 v[128:131], v2, s[20:23], s44 offen
v_mfma_f32_16x16x32_bf16 v[180:183], v[40:43], v[20:23], v[180:183]
v_mfma_f32_16x16x32_bf16 v[184:187], v[44:47], v[20:23], v[184:187]
buffer_load_dwordx4 v[144:147], v2, s[20:23], s48 offen
v_mfma_f32_16x16x32_bf16 v[188:191], v[48:51], v[20:23], v[188:191]
v_mfma_f32_16x16x32_bf16 v[192:195], v[52:55], v[20:23], v[192:195]
buffer_load_dwordx4 v[132:135], v2, s[20:23], s45 offen
v_mfma_f32_16x16x32_bf16 v[196:199], v[36:39], v[24:27], v[196:199]
v_mfma_f32_16x16x32_bf16 v[200:203], v[40:43], v[24:27], v[200:203]
buffer_load_dwordx4 v[148:151], v2, s[20:23], s49 offen
v_mfma_f32_16x16x32_bf16 v[204:207], v[44:47], v[24:27], v[204:207]
v_mfma_f32_16x16x32_bf16 v[208:211], v[48:51], v[24:27], v[208:211]
buffer_load_dwordx4 v[136:139], v2, s[20:23], s46 offen
v_mfma_f32_16x16x32_bf16 v[212:215], v[52:55], v[24:27], v[212:215]
v_mfma_f32_16x16x32_bf16 v[216:219], v[36:39], v[28:31], v[216:219]
buffer_load_dwordx4 v[152:155], v2, s[20:23], s50 offen
v_mfma_f32_16x16x32_bf16 v[220:223], v[40:43], v[28:31], v[220:223]
v_mfma_f32_16x16x32_bf16 v[224:227], v[44:47], v[28:31], v[224:227]
buffer_load_dwordx4 v[140:143], v2, s[20:23], s47 offen
v_mfma_f32_16x16x32_bf16 v[228:231], v[48:51], v[28:31], v[228:231]
v_mfma_f32_16x16x32_bf16 v[232:235], v[52:55], v[28:31], v[232:235]
buffer_load_dwordx4 v[156:159], v2, s[20:23], s51 offen
v_mfma_f32_16x16x32_bf16 v[236:239], v[36:39], v[32:35], v[236:239]
v_mfma_f32_16x16x32_bf16 v[240:243], v[40:43], v[32:35], v[240:243]
buffer_load_dwordx4 v[160:163], v2, s[20:23], s52 offen
v_mfma_f32_16x16x32_bf16 v[244:247], v[44:47], v[32:35], v[244:247]
v_mfma_f32_16x16x32_bf16 v[248:251], v[48:51], v[32:35], v[248:251]
s_add_u32 s20, s20, 1024
s_addc_u32 s21, s21, 0
v_mfma_f32_16x16x32_bf16 v[252:255], v[52:55], v[32:35], v[252:255]
s_waitcnt vmcnt(18)
v_mfma_f32_16x16x32_bf16 v[176:179], v[72:75], v[56:59], v[176:179]
buffer_load_dwordx4 v[20:23], v2, s[20:23], s44 offen
v_mfma_f32_16x16x32_bf16 v[180:183], v[76:79], v[56:59], v[180:183]
v_mfma_f32_16x16x32_bf16 v[184:187], v[80:83], v[56:59], v[184:187]
buffer_load_dwordx4 v[36:39], v2, s[20:23], s48 offen
v_mfma_f32_16x16x32_bf16 v[188:191], v[84:87], v[56:59], v[188:191]
v_mfma_f32_16x16x32_bf16 v[192:195], v[88:91], v[56:59], v[192:195]
buffer_load_dwordx4 v[24:27], v2, s[20:23], s45 offen
v_mfma_f32_16x16x32_bf16 v[196:199], v[72:75], v[60:63], v[196:199]
v_mfma_f32_16x16x32_bf16 v[200:203], v[76:79], v[60:63], v[200:203]
buffer_load_dwordx4 v[40:43], v2, s[20:23], s49 offen
v_mfma_f32_16x16x32_bf16 v[204:207], v[80:83], v[60:63], v[204:207]
v_mfma_f32_16x16x32_bf16 v[208:211], v[84:87], v[60:63], v[208:211]
buffer_load_dwordx4 v[28:31], v2, s[20:23], s46 offen
v_mfma_f32_16x16x32_bf16 v[212:215], v[88:91], v[60:63], v[212:215]
v_mfma_f32_16x16x32_bf16 v[216:219], v[72:75], v[64:67], v[216:219]
buffer_load_dwordx4 v[44:47], v2, s[20:23], s50 offen
v_mfma_f32_16x16x32_bf16 v[220:223], v[76:79], v[64:67], v[220:223]
v_mfma_f32_16x16x32_bf16 v[224:227], v[80:83], v[64:67], v[224:227]
buffer_load_dwordx4 v[32:35], v2, s[20:23], s47 offen
v_mfma_f32_16x16x32_bf16 v[228:231], v[84:87], v[64:67], v[228:231]
v_mfma_f32_16x16x32_bf16 v[232:235], v[88:91], v[64:67], v[232:235]
buffer_load_dwordx4 v[48:51], v2, s[20:23], s51 offen
v_mfma_f32_16x16x32_bf16 v[236:239], v[72:75], v[68:71], v[236:239]
v_mfma_f32_16x16x32_bf16 v[240:243], v[76:79], v[68:71], v[240:243]
buffer_load_dwordx4 v[52:55], v2, s[20:23], s52 offen
v_mfma_f32_16x16x32_bf16 v[244:247], v[80:83], v[68:71], v[244:247]
v_mfma_f32_16x16x32_bf16 v[248:251], v[84:87], v[68:71], v[248:251]
s_add_u32 s20, s20, 1024
s_addc_u32 s21, s21, 0
v_mfma_f32_16x16x32_bf16 v[252:255], v[88:91], v[68:71], v[252:255]
s_waitcnt vmcnt(18)
v_mfma_f32_16x16x32_bf16 v[176:179], v[108:111], v[92:95], v[176:179]
s_cmp_ge_u32 s40, 2
s_cselect_b32 s22, 0, s22
v_mfma_f32_16x16x32_bf16 v[180:183], v[112:115], v[92:95], v[180:183]
buffer_load_dwordx4 v[56:59], v2, s[20:23], s44 offen
v_mfma_f32_16x16x32_bf16 v[184:187], v[116:119], v[92:95], v[184:187]
v_mfma_f32_16x16x32_bf16 v[188:191], v[120:123], v[92:95], v[188:191]
buffer_load_dwordx4 v[72:75], v2, s[20:23], s48 offen
v_mfma_f32_16x16x32_bf16 v[192:195], v[124:127], v[92:95], v[192:195]
v_mfma_f32_16x16x32_bf16 v[196:199], v[108:111], v[96:99], v[196:199]
buffer_load_dwordx4 v[60:63], v2, s[20:23], s45 offen
v_mfma_f32_16x16x32_bf16 v[200:203], v[112:115], v[96:99], v[200:203]
v_mfma_f32_16x16x32_bf16 v[204:207], v[116:119], v[96:99], v[204:207]
buffer_load_dwordx4 v[76:79], v2, s[20:23], s49 offen
v_mfma_f32_16x16x32_bf16 v[208:211], v[120:123], v[96:99], v[208:211]
v_mfma_f32_16x16x32_bf16 v[212:215], v[124:127], v[96:99], v[212:215]
buffer_load_dwordx4 v[64:67], v2, s[20:23], s46 offen
v_mfma_f32_16x16x32_bf16 v[216:219], v[108:111], v[100:103], v[216:219]
buffer_load_dwordx4 v[80:83], v2, s[20:23], s50 offen
v_mfma_f32_16x16x32_bf16 v[220:223], v[112:115], v[100:103], v[220:223]
v_mfma_f32_16x16x32_bf16 v[224:227], v[116:119], v[100:103], v[224:227]
buffer_load_dwordx4 v[68:71], v2, s[20:23], s47 offen
v_mfma_f32_16x16x32_bf16 v[228:231], v[120:123], v[100:103], v[228:231]
v_mfma_f32_16x16x32_bf16 v[232:235], v[124:127], v[100:103], v[232:235]
buffer_load_dwordx4 v[84:87], v2, s[20:23], s51 offen
v_mfma_f32_16x16x32_bf16 v[236:239], v[108:111], v[104:107], v[236:239]
v_mfma_f32_16x16x32_bf16 v[240:243], v[112:115], v[104:107], v[240:243]
buffer_load_dwordx4 v[88:91], v2, s[20:23], s52 offen
v_mfma_f32_16x16x32_bf16 v[244:247], v[116:119], v[104:107], v[244:247]
v_mfma_f32_16x16x32_bf16 v[248:251], v[120:123], v[104:107], v[248:251]
s_add_u32 s20, s20, 1024
s_addc_u32 s21, s21, 0
v_mfma_f32_16x16x32_bf16 v[252:255], v[124:127], v[104:107], v[252:255]
s_waitcnt vmcnt(18)
v_mfma_f32_16x16x32_bf16 v[176:179], v[144:147], v[128:131], v[176:179]
s_mul_i32 s55, s71, 370
v_mfma_f32_16x16x32_bf16 v[180:183], v[148:151], v[128:131], v[180:183]
s_mul_i32 s54, s40, 5
v_mfma_f32_16x16x32_bf16 v[184:187], v[152:155], v[128:131], v[184:187]
s_add_u32 s55, s55, s54
v_mfma_f32_16x16x32_bf16 v[188:191], v[156:159], v[128:131], v[188:191]
v_mfma_f32_16x16x32_bf16 v[192:195], v[160:163], v[128:131], v[192:195]
s_add_u32 s55, s55, 54
v_mfma_f32_16x16x32_bf16 v[196:199], v[144:147], v[132:135], v[196:199]
s_lshl_b32 s55, s55, 10
v_mfma_f32_16x16x32_bf16 v[200:203], v[148:151], v[132:135], v[200:203]
s_add_u32 s48, s55, 15728640
v_mfma_f32_16x16x32_bf16 v[204:207], v[152:155], v[132:135], v[204:207]
v_mfma_f32_16x16x32_bf16 v[208:211], v[156:159], v[132:135], v[208:211]
s_add_u32 s49, s48, 75776
v_mfma_f32_16x16x32_bf16 v[212:215], v[160:163], v[132:135], v[212:215]
s_add_u32 s50, s48, 151552
v_mfma_f32_16x16x32_bf16 v[216:219], v[144:147], v[136:139], v[216:219]
s_add_u32 s51, s48, 227328
v_mfma_f32_16x16x32_bf16 v[220:223], v[148:151], v[136:139], v[220:223]
v_mfma_f32_16x16x32_bf16 v[224:227], v[152:155], v[136:139], v[224:227]
s_add_u32 s52, s48, 303104
v_mfma_f32_16x16x32_bf16 v[228:231], v[156:159], v[136:139], v[228:231]
buffer_load_dwordx4 v[108:111], v2, s[16:19], s48 offen offset:0
v_mfma_f32_16x16x32_bf16 v[232:235], v[160:163], v[136:139], v[232:235]
buffer_load_dwordx4 v[112:115], v2, s[16:19], s49 offen offset:0
v_mfma_f32_16x16x32_bf16 v[236:239], v[144:147], v[140:143], v[236:239]
v_mfma_f32_16x16x32_bf16 v[240:243], v[148:151], v[140:143], v[240:243]
buffer_load_dwordx4 v[116:119], v2, s[16:19], s50 offen offset:0
v_mfma_f32_16x16x32_bf16 v[244:247], v[152:155], v[140:143], v[244:247]
buffer_load_dwordx4 v[120:123], v2, s[16:19], s51 offen offset:0
v_mfma_f32_16x16x32_bf16 v[248:251], v[156:159], v[140:143], v[248:251]
buffer_load_dwordx4 v[124:127], v2, s[16:19], s52 offen offset:0
v_mfma_f32_16x16x32_bf16 v[252:255], v[160:163], v[140:143], v[252:255]
s_waitcnt vmcnt(14)
v_mfma_f32_16x16x32_bf16 v[176:179], v[36:39], v[20:23], v[176:179]
buffer_load_dwordx4 v[144:147], v2, s[16:19], s48 offen offset:1024
v_and_b32 v3, 7, v1
v_mfma_f32_16x16x32_bf16 v[180:183], v[40:43], v[20:23], v[180:183]
v_mfma_f32_16x16x32_bf16 v[184:187], v[44:47], v[20:23], v[184:187]
v_mov_b32 v4, 40
v_mfma_f32_16x16x32_bf16 v[188:191], v[48:51], v[20:23], v[188:191]
v_mfma_f32_16x16x32_bf16 v[192:195], v[52:55], v[20:23], v[192:195]
buffer_load_dwordx4 v[148:151], v2, s[16:19], s49 offen offset:1024
v_mfma_f32_16x16x32_bf16 v[196:199], v[36:39], v[24:27], v[196:199]
v_lshlrev_b32 v3, 7, v3
v_mfma_f32_16x16x32_bf16 v[200:203], v[40:43], v[24:27], v[200:203]
v_mfma_f32_16x16x32_bf16 v[204:207], v[44:47], v[24:27], v[204:207]
s_and_b32 s57, s2, 31
v_mfma_f32_16x16x32_bf16 v[208:211], v[48:51], v[24:27], v[208:211]
buffer_load_dwordx4 v[152:155], v2, s[16:19], s50 offen offset:1024
v_mfma_f32_16x16x32_bf16 v[212:215], v[52:55], v[24:27], v[212:215]
v_mfma_f32_16x16x32_bf16 v[216:219], v[36:39], v[28:31], v[216:219]
s_lshl_b32 s57, s57, 10
v_mfma_f32_16x16x32_bf16 v[220:223], v[40:43], v[28:31], v[220:223]
v_mfma_f32_16x16x32_bf16 v[224:227], v[44:47], v[28:31], v[224:227]
buffer_load_dwordx4 v[156:159], v2, s[16:19], s51 offen offset:1024
s_add_u32 s43, s57, 262144
v_mfma_f32_16x16x32_bf16 v[228:231], v[48:51], v[28:31], v[228:231]
v_mfma_f32_16x16x32_bf16 v[232:235], v[52:55], v[28:31], v[232:235]
v_mfma_f32_16x16x32_bf16 v[236:239], v[36:39], v[32:35], v[236:239]
s_cmp_eq_u32 s40, 0
s_cselect_b32 s57, s43, 0x40000000
v_mfma_f32_16x16x32_bf16 v[240:243], v[40:43], v[32:35], v[240:243]
buffer_load_dwordx4 v[160:163], v2, s[16:19], s52 offen offset:1024
v_mfma_f32_16x16x32_bf16 v[244:247], v[44:47], v[32:35], v[244:247]
buffer_load_dword v5, v3, s[16:19], s57 offen sc1
v_mfma_f32_16x16x32_bf16 v[248:251], v[48:51], v[32:35], v[248:251]
v_mfma_f32_16x16x32_bf16 v[252:255], v[52:55], v[32:35], v[252:255]
s_waitcnt vmcnt(11)
v_mfma_f32_16x16x32_bf16 v[176:179], v[72:75], v[56:59], v[176:179]
buffer_load_dwordx4 v[36:39], v2, s[16:19], s48 offen offset:2048
v_mfma_f32_16x16x32_bf16 v[180:183], v[76:79], v[56:59], v[180:183]
v_mfma_f32_16x16x32_bf16 v[184:187], v[80:83], v[56:59], v[184:187]
v_mfma_f32_16x16x32_bf16 v[188:191], v[84:87], v[56:59], v[188:191]
v_mfma_f32_16x16x32_bf16 v[192:195], v[88:91], v[56:59], v[192:195]
buffer_load_dwordx4 v[40:43], v2, s[16:19], s49 offen offset:2048
v_mfma_f32_16x16x32_bf16 v[196:199], v[72:75], v[60:63], v[196:199]
v_mfma_f32_16x16x32_bf16 v[200:203], v[76:79], v[60:63], v[200:203]
v_mfma_f32_16x16x32_bf16 v[204:207], v[80:83], v[60:63], v[204:207]
v_mfma_f32_16x16x32_bf16 v[208:211], v[84:87], v[60:63], v[208:211]
buffer_load_dwordx4 v[44:47], v2, s[16:19], s50 offen offset:2048
v_mfma_f32_16x16x32_bf16 v[212:215], v[88:91], v[60:63], v[212:215]
v_mfma_f32_16x16x32_bf16 v[216:219], v[72:75], v[64:67], v[216:219]
v_mfma_f32_16x16x32_bf16 v[220:223], v[76:79], v[64:67], v[220:223]
v_mfma_f32_16x16x32_bf16 v[224:227], v[80:83], v[64:67], v[224:227]
buffer_load_dwordx4 v[48:51], v2, s[16:19], s51 offen offset:2048
v_mfma_f32_16x16x32_bf16 v[228:231], v[84:87], v[64:67], v[228:231]
v_mfma_f32_16x16x32_bf16 v[232:235], v[88:91], v[64:67], v[232:235]
v_mfma_f32_16x16x32_bf16 v[236:239], v[72:75], v[68:71], v[236:239]
v_mfma_f32_16x16x32_bf16 v[240:243], v[76:79], v[68:71], v[240:243]
buffer_load_dwordx4 v[52:55], v2, s[16:19], s52 offen offset:2048
v_mfma_f32_16x16x32_bf16 v[244:247], v[80:83], v[68:71], v[244:247]
v_mfma_f32_16x16x32_bf16 v[248:251], v[84:87], v[68:71], v[248:251]
v_mfma_f32_16x16x32_bf16 v[252:255], v[88:91], v[68:71], v[252:255]
buffer_load_dwordx4 v[72:75], v2, s[16:19], s48 offen offset:3072
buffer_load_dwordx4 v[76:79], v2, s[16:19], s49 offen offset:3072
buffer_load_dwordx4 v[80:83], v2, s[16:19], s50 offen offset:3072
buffer_load_dwordx4 v[84:87], v2, s[16:19], s51 offen offset:3072
buffer_load_dwordx4 v[88:91], v2, s[16:19], s52 offen offset:3072
s_cmp_lg_u32 s40, 0
s_cbranch_scc1 K2_SPUN
s_waitcnt vmcnt(10)
v_cmp_ne_u32 vcc, v4, v5
s_cbranch_vccz K2_SPUN
s_mov_b32 s55, 0
K2_SPINL:
s_sleep 4
buffer_load_dword v5, v3, s[16:19], s43 offen sc1
s_add_u32 s55, s55, 1
s_waitcnt vmcnt(0)
v_cmp_ne_u32 vcc, v4, v5
s_cmp_ge_u32 s55, 100000
s_cbranch_scc1 K2_SPUN
s_cbranch_vccnz K2_SPINL
K2_SPUN:
s_barrier
s_add_u32 m0, s59, 0
s_nop 0
buffer_load_dwordx4 v16, s[16:19], s53 offen sc1 lds
s_add_u32 s53, s53, 32768
s_add_u32 m0, s59, 1024
s_nop 0
buffer_load_dwordx4 v17, s[16:19], s53 offen sc1 lds
s_add_u32 s53, s53, 32768
s_add_u32 m0, s59, 2048
s_nop 0
buffer_load_dwordx4 v16, s[16:19], s53 offen sc1 lds
s_add_u32 s53, s53, 32768
s_add_u32 m0, s59, 3072
s_nop 0
buffer_load_dwordx4 v17, s[16:19], s53 offen sc1 lds
s_add_u32 s53, s53, 32768
s_add_u32 m0, s59, 4096
s_nop 0
buffer_load_dwordx4 v16, s[16:19], s53 offen sc1 lds
s_add_u32 s53, s53, 32768
s_add_u32 m0, s59, 5120
s_nop 0
buffer_load_dwordx4 v17, s[16:19], s53 offen sc1 lds
s_add_u32 s53, s53, 32768
s_add_u32 m0, s59, 6144
s_nop 0
buffer_load_dwordx4 v16, s[16:19], s53 offen sc1 lds
s_add_u32 s53, s53, 32768
s_add_u32 m0, s59, 7168
s_nop 0
buffer_load_dwordx4 v17, s[16:19], s53 offen sc1 lds
s_add_u32 s53, s53, 32768
s_add_u32 m0, s59, 8192
s_nop 0
buffer_load_dwordx4 v16, s[16:19], s53 offen sc1 lds
s_add_u32 s53, s53, 32768
s_add_u32 m0, s59, 9216
s_nop 0
buffer_load_dwordx4 v17, s[16:19], s53 offen sc1 lds
s_add_u32 s53, s53, 32768
s_add_u32 m0, s59, 10240
s_nop 0
buffer_load_dwordx4 v16, s[16:19], s53 offen sc1 lds
s_add_u32 s53, s53, 32768
s_add_u32 m0, s59, 11264
s_nop 0
buffer_load_dwordx4 v17, s[16:19], s53 offen sc1 lds
s_add_u32 s53, s53, 32768
s_add_u32 m0, s59, 12288
s_nop 0
buffer_load_dwordx4 v16, s[16:19], s53 offen sc1 lds
s_add_u32 s53, s53, 32768
s_add_u32 m0, s59, 13312
s_nop 0
buffer_load_dwordx4 v17, s[16:19], s53 offen sc1 lds
s_add_u32 s53, s53, 32768
s_add_u32 m0, s59, 14336
s_nop 0
buffer_load_dwordx4 v16, s[16:19], s53 offen sc1 lds
s_add_u32 s53, s53, 32768
s_add_u32 m0, s59, 15360
s_nop 0
buffer_load_dwordx4 v17, s[16:19], s53 offen sc1 lds
s_add_u32 s53, s53, 32768
s_add_u32 m0, s59, 16384
s_nop 0
buffer_load_dwordx4 v16, s[16:19], s53 offen sc1 lds
s_add_u32 s53, s53, 32768
s_add_u32 m0, s59, 17408
s_nop 0
buffer_load_dwordx4 v17, s[16:19], s53 offen sc1 lds
s_add_u32 s53, s53, 32768
s_add_u32 m0, s59, 18432
s_nop 0
buffer_load_dwordx4 v16, s[16:19], s53 offen sc1 lds
s_add_u32 s53, s53, 32768
s_add_u32 m0, s59, 19456
s_nop 0
buffer_load_dwordx4 v17, s[16:19], s53 offen sc1 lds
s_waitcnt vmcnt(16)
ds_read_b64_tr_b16 v[92:93], v12 offset:0
ds_read_b64_tr_b16 v[94:95], v12 offset:512
ds_read_b64_tr_b16 v[96:97], v13 offset:0
ds_read_b64_tr_b16 v[98:99], v13 offset:512
ds_read_b64_tr_b16 v[100:101], v14 offset:0
ds_read_b64_tr_b16 v[102:103], v14 offset:512
ds_read_b64_tr_b16 v[104:105], v15 offset:0
ds_read_b64_tr_b16 v[106:107], v15 offset:512
s_waitcnt lgkmcnt(0)
v_mfma_f32_16x16x32_bf16 v[176:179], v[108:111], v[92:95], v[176:179]
s_waitcnt vmcnt(12)
ds_read_b64_tr_b16 v[128:129], v12 offset:4096
v_mfma_f32_16x16x32_bf16 v[180:183], v[112:115], v[92:95], v[180:183]
ds_read_b64_tr_b16 v[130:131], v12 offset:4608
v_mfma_f32_16x16x32_bf16 v[184:187], v[116:119], v[92:95], v[184:187]
v_mfma_f32_16x16x32_bf16 v[188:191], v[120:123], v[92:95], v[188:191]
ds_read_b64_tr_b16 v[132:133], v13 offset:4096
v_mfma_f32_16x16x32_bf16 v[192:195], v[124:127], v[92:95], v[192:195]
v_mfma_f32_16x16x32_bf16 v[196:199], v[108:111], v[96:99], v[196:199]
ds_read_b64_tr_b16 v[134:135], v13 offset:4608
v_mfma_f32_16x16x32_bf16 v[200:203], v[112:115], v[96:99], v[200:203]
v_mfma_f32_16x16x32_bf16 v[204:207], v[116:119], v[96:99], v[204:207]
ds_read_b64_tr_b16 v[136:137], v14 offset:4096
v_mfma_f32_16x16x32_bf16 v[208:211], v[120:123], v[96:99], v[208:211]
v_mfma_f32_16x16x32_bf16 v[212:215], v[124:127], v[96:99], v[212:215]
ds_read_b64_tr_b16 v[138:139], v14 offset:4608
v_mfma_f32_16x16x32_bf16 v[216:219], v[108:111], v[100:103], v[216:219]
v_mfma_f32_16x16x32_bf16 v[220:223], v[112:115], v[100:103], v[220:223]
ds_read_b64_tr_b16 v[140:141], v15 offset:4096
v_mfma_f32_16x16x32_bf16 v[224:227], v[116:119], v[100:103], v[224:227]
v_mfma_f32_16x16x32_bf16 v[228:231], v[120:123], v[100:103], v[228:231]
ds_read_b64_tr_b16 v[142:143], v15 offset:4608
v_mfma_f32_16x16x32_bf16 v[232:235], v[124:127], v[100:103], v[232:235]
v_mfma_f32_16x16x32_bf16 v[236:239], v[108:111], v[104:107], v[236:239]
v_mfma_f32_16x16x32_bf16 v[240:243], v[112:115], v[104:107], v[240:243]
v_mfma_f32_16x16x32_bf16 v[244:247], v[116:119], v[104:107], v[244:247]
v_mfma_f32_16x16x32_bf16 v[248:251], v[120:123], v[104:107], v[248:251]
v_mfma_f32_16x16x32_bf16 v[252:255], v[124:127], v[104:107], v[252:255]
s_waitcnt lgkmcnt(0)
v_mfma_f32_16x16x32_bf16 v[176:179], v[144:147], v[128:131], v[176:179]
s_waitcnt vmcnt(8)
ds_read_b64_tr_b16 v[20:21], v12 offset:8192
s_add_u32 s48, s48, 4096
v_mfma_f32_16x16x32_bf16 v[180:183], v[148:151], v[128:131], v[180:183]
ds_read_b64_tr_b16 v[22:23], v12 offset:8704
v_mfma_f32_16x16x32_bf16 v[184:187], v[152:155], v[128:131], v[184:187]
s_add_u32 s49, s49, 4096
v_mfma_f32_16x16x32_bf16 v[188:191], v[156:159], v[128:131], v[188:191]
ds_read_b64_tr_b16 v[24:25], v13 offset:8192
v_mfma_f32_16x16x32_bf16 v[192:195], v[160:163], v[128:131], v[192:195]
s_add_u32 s50, s50, 4096
v_mfma_f32_16x16x32_bf16 v[196:199], v[144:147], v[132:135], v[196:199]
ds_read_b64_tr_b16 v[26:27], v13 offset:8704
v_mfma_f32_16x16x32_bf16 v[200:203], v[148:151], v[132:135], v[200:203]
s_add_u32 s51, s51, 4096
v_mfma_f32_16x16x32_bf16 v[204:207], v[152:155], v[132:135], v[204:207]
ds_read_b64_tr_b16 v[28:29], v14 offset:8192
v_mfma_f32_16x16x32_bf16 v[208:211], v[156:159], v[132:135], v[208:211]
s_add_u32 s52, s52, 4096
v_mfma_f32_16x16x32_bf16 v[212:215], v[160:163], v[132:135], v[212:215]
ds_read_b64_tr_b16 v[30:31], v14 offset:8704
v_mfma_f32_16x16x32_bf16 v[216:219], v[144:147], v[136:139], v[216:219]
buffer_load_dwordx4 v[108:111], v2, s[16:19], s48 offen offset:0
v_mfma_f32_16x16x32_bf16 v[220:223], v[148:151], v[136:139], v[220:223]
ds_read_b64_tr_b16 v[32:33], v15 offset:8192
v_mfma_f32_16x16x32_bf16 v[224:227], v[152:155], v[136:139], v[224:227]
buffer_load_dwordx4 v[112:115], v2, s[16:19], s49 offen offset:0
v_mfma_f32_16x16x32_bf16 v[228:231], v[156:159], v[136:139], v[228:231]
ds_read_b64_tr_b16 v[34:35], v15 offset:8704
v_mfma_f32_16x16x32_bf16 v[232:235], v[160:163], v[136:139], v[232:235]
buffer_load_dwordx4 v[116:119], v2, s[16:19], s50 offen offset:0
v_mfma_f32_16x16x32_bf16 v[236:239], v[144:147], v[140:143], v[236:239]
v_mfma_f32_16x16x32_bf16 v[240:243], v[148:151], v[140:143], v[240:243]
buffer_load_dwordx4 v[120:123], v2, s[16:19], s51 offen offset:0
v_mfma_f32_16x16x32_bf16 v[244:247], v[152:155], v[140:143], v[244:247]
v_mfma_f32_16x16x32_bf16 v[248:251], v[156:159], v[140:143], v[248:251]
buffer_load_dwordx4 v[124:127], v2, s[16:19], s52 offen offset:0
v_mfma_f32_16x16x32_bf16 v[252:255], v[160:163], v[140:143], v[252:255]
s_waitcnt lgkmcnt(0)
v_mfma_f32_16x16x32_bf16 v[176:179], v[36:39], v[20:23], v[176:179]
s_waitcnt vmcnt(9)
ds_read_b64_tr_b16 v[56:57], v12 offset:12288
buffer_load_dwordx2 v[128:129], v169, s[8:11], s58 offen
v_mfma_f32_16x16x32_bf16 v[180:183], v[40:43], v[20:23], v[180:183]
ds_read_b64_tr_b16 v[58:59], v12 offset:12800
v_mfma_f32_16x16x32_bf16 v[184:187], v[44:47], v[20:23], v[184:187]
v_mfma_f32_16x16x32_bf16 v[188:191], v[48:51], v[20:23], v[188:191]
ds_read_b64_tr_b16 v[60:61], v13 offset:12288
v_mfma_f32_16x16x32_bf16 v[192:195], v[52:55], v[20:23], v[192:195]
buffer_load_dwordx2 v[130:131], v170, s[8:11], s58 offen
v_mfma_f32_16x16x32_bf16 v[196:199], v[36:39], v[24:27], v[196:199]
ds_read_b64_tr_b16 v[62:63], v13 offset:12800
v_mfma_f32_16x16x32_bf16 v[200:203], v[40:43], v[24:27], v[200:203]
v_mfma_f32_16x16x32_bf16 v[204:207], v[44:47], v[24:27], v[204:207]
ds_read_b64_tr_b16 v[64:65], v14 offset:12288
v_mfma_f32_16x16x32_bf16 v[208:211], v[48:51], v[24:27], v[208:211]
buffer_load_dwordx2 v[132:133], v171, s[8:11], s58 offen
v_mfma_f32_16x16x32_bf16 v[212:215], v[52:55], v[24:27], v[212:215]
ds_read_b64_tr_b16 v[66:67], v14 offset:12800
v_mfma_f32_16x16x32_bf16 v[216:219], v[36:39], v[28:31], v[216:219]
v_mfma_f32_16x16x32_bf16 v[220:223], v[40:43], v[28:31], v[220:223]
ds_read_b64_tr_b16 v[68:69], v15 offset:12288
v_mfma_f32_16x16x32_bf16 v[224:227], v[44:47], v[28:31], v[224:227]
buffer_load_dwordx2 v[134:135], v172, s[8:11], s58 offen
v_mfma_f32_16x16x32_bf16 v[228:231], v[48:51], v[28:31], v[228:231]
ds_read_b64_tr_b16 v[70:71], v15 offset:12800
v_mfma_f32_16x16x32_bf16 v[232:235], v[52:55], v[28:31], v[232:235]
v_mfma_f32_16x16x32_bf16 v[236:239], v[36:39], v[32:35], v[236:239]
v_mfma_f32_16x16x32_bf16 v[240:243], v[40:43], v[32:35], v[240:243]
buffer_load_dwordx2 v[136:137], v173, s[8:11], s58 offen
v_mfma_f32_16x16x32_bf16 v[244:247], v[44:47], v[32:35], v[244:247]
v_mfma_f32_16x16x32_bf16 v[248:251], v[48:51], v[32:35], v[248:251]
v_mfma_f32_16x16x32_bf16 v[252:255], v[52:55], v[32:35], v[252:255]
s_waitcnt lgkmcnt(0)
v_mfma_f32_16x16x32_bf16 v[176:179], v[72:75], v[56:59], v[176:179]
s_waitcnt vmcnt(10)
ds_read_b64_tr_b16 v[92:93], v12 offset:16384
v_mfma_f32_16x16x32_bf16 v[180:183], v[76:79], v[56:59], v[180:183]
ds_read_b64_tr_b16 v[94:95], v12 offset:16896
v_mfma_f32_16x16x32_bf16 v[184:187], v[80:83], v[56:59], v[184:187]
v_mfma_f32_16x16x32_bf16 v[188:191], v[84:87], v[56:59], v[188:191]
ds_read_b64_tr_b16 v[96:97], v13 offset:16384
v_mfma_f32_16x16x32_bf16 v[192:195], v[88:91], v[56:59], v[192:195]
v_mfma_f32_16x16x32_bf16 v[196:199], v[72:75], v[60:63], v[196:199]
ds_read_b64_tr_b16 v[98:99], v13 offset:16896
v_mfma_f32_16x16x32_bf16 v[200:203], v[76:79], v[60:63], v[200:203]
v_mfma_f32_16x16x32_bf16 v[204:207], v[80:83], v[60:63], v[204:207]
ds_read_b64_tr_b16 v[100:101], v14 offset:16384
v_mfma_f32_16x16x32_bf16 v[208:211], v[84:87], v[60:63], v[208:211]
v_mfma_f32_16x16x32_bf16 v[212:215], v[88:91], v[60:63], v[212:215]
ds_read_b64_tr_b16 v[102:103], v14 offset:16896
v_mfma_f32_16x16x32_bf16 v[216:219], v[72:75], v[64:67], v[216:219]
v_mfma_f32_16x16x32_bf16 v[220:223], v[76:79], v[64:67], v[220:223]
ds_read_b64_tr_b16 v[104:105], v15 offset:16384
v_mfma_f32_16x16x32_bf16 v[224:227], v[80:83], v[64:67], v[224:227]
v_mfma_f32_16x16x32_bf16 v[228:231], v[84:87], v[64:67], v[228:231]
ds_read_b64_tr_b16 v[106:107], v15 offset:16896
v_mfma_f32_16x16x32_bf16 v[232:235], v[88:91], v[64:67], v[232:235]
v_mfma_f32_16x16x32_bf16 v[236:239], v[72:75], v[68:71], v[236:239]
v_mfma_f32_16x16x32_bf16 v[240:243], v[76:79], v[68:71], v[240:243]
v_mfma_f32_16x16x32_bf16 v[244:247], v[80:83], v[68:71], v[244:247]
v_mfma_f32_16x16x32_bf16 v[248:251], v[84:87], v[68:71], v[248:251]
v_mfma_f32_16x16x32_bf16 v[252:255], v[88:91], v[68:71], v[252:255]
s_waitcnt lgkmcnt(0)
s_waitcnt vmcnt(5)
v_mfma_f32_16x16x32_bf16 v[176:179], v[108:111], v[92:95], v[176:179]
v_mfma_f32_16x16x32_bf16 v[180:183], v[112:115], v[92:95], v[180:183]
v_mfma_f32_16x16x32_bf16 v[184:187], v[116:119], v[92:95], v[184:187]
v_mfma_f32_16x16x32_bf16 v[188:191], v[120:123], v[92:95], v[188:191]
v_mfma_f32_16x16x32_bf16 v[192:195], v[124:127], v[92:95], v[192:195]
v_mfma_f32_16x16x32_bf16 v[196:199], v[108:111], v[96:99], v[196:199]
v_mfma_f32_16x16x32_bf16 v[200:203], v[112:115], v[96:99], v[200:203]
v_mfma_f32_16x16x32_bf16 v[204:207], v[116:119], v[96:99], v[204:207]
v_mfma_f32_16x16x32_bf16 v[208:211], v[120:123], v[96:99], v[208:211]
v_mfma_f32_16x16x32_bf16 v[212:215], v[124:127], v[96:99], v[212:215]
v_mfma_f32_16x16x32_bf16 v[216:219], v[108:111], v[100:103], v[216:219]
v_mfma_f32_16x16x32_bf16 v[220:223], v[112:115], v[100:103], v[220:223]
v_mfma_f32_16x16x32_bf16 v[224:227], v[116:119], v[100:103], v[224:227]
v_mfma_f32_16x16x32_bf16 v[228:231], v[120:123], v[100:103], v[228:231]
v_mfma_f32_16x16x32_bf16 v[232:235], v[124:127], v[100:103], v[232:235]
v_mfma_f32_16x16x32_bf16 v[236:239], v[108:111], v[104:107], v[236:239]
v_mfma_f32_16x16x32_bf16 v[240:243], v[112:115], v[104:107], v[240:243]
v_mfma_f32_16x16x32_bf16 v[244:247], v[116:119], v[104:107], v[244:247]
v_mfma_f32_16x16x32_bf16 v[248:251], v[120:123], v[104:107], v[248:251]
v_mfma_f32_16x16x32_bf16 v[252:255], v[124:127], v[104:107], v[252:255]
v_and_b32 v8, 15, v1
v_lshrrev_b32 v9, 4, v1
v_mul_u32_u24 v10, 336, v8
v_lshl_add_u32 v10, v9, 4, v10
v_add_u32 v10, s59, v10
ds_write_b128 v10, v[176:179] offset:0
ds_write_b128 v10, v[180:183] offset:64
ds_write_b128 v10, v[184:187] offset:128
ds_write_b128 v10, v[188:191] offset:192
ds_write_b128 v10, v[192:195] offset:256
ds_write_b128 v10, v[196:199] offset:5376
ds_write_b128 v10, v[200:203] offset:5440
ds_write_b128 v10, v[204:207] offset:5504
ds_write_b128 v10, v[208:211] offset:5568
ds_write_b128 v10, v[212:215] offset:5632
ds_write_b128 v10, v[216:219] offset:10752
ds_write_b128 v10, v[220:223] offset:10816
ds_write_b128 v10, v[224:227] offset:10880
ds_write_b128 v10, v[228:231] offset:10944
ds_write_b128 v10, v[232:235] offset:11008
ds_write_b128 v10, v[236:239] offset:16128
ds_write_b128 v10, v[240:243] offset:16192
ds_write_b128 v10, v[244:247] offset:16256
ds_write_b128 v10, v[248:251] offset:16320
ds_write_b128 v10, v[252:255] offset:16384
s_waitcnt lgkmcnt(0)
s_barrier
ds_read_b128 v[20:23], v164 offset:0
ds_read_b128 v[24:27], v164 offset:21504
ds_read_b128 v[28:31], v164 offset:43008
ds_read_b128 v[32:35], v164 offset:64512
ds_read_b128 v[36:39], v165 offset:0
ds_read_b128 v[40:43], v165 offset:21504
ds_read_b128 v[44:47], v165 offset:43008
ds_read_b128 v[48:51], v165 offset:64512
ds_read_b128 v[52:55], v166 offset:0
ds_read_b128 v[56:59], v166 offset:21504
ds_read_b128 v[60:63], v166 offset:43008
ds_read_b128 v[64:67], v166 offset:64512
ds_read_b128 v[68:71], v167 offset:0
ds_read_b128 v[72:75], v167 offset:21504
ds_read_b128 v[76:79], v167 offset:43008
ds_read_b128 v[80:83], v167 offset:64512
ds_read_b128 v[84:87], v168 offset:0
ds_read_b128 v[88:91], v168 offset:21504
ds_read_b128 v[92:95], v168 offset:43008
ds_read_b128 v[96:99], v168 offset:64512
s_waitcnt vmcnt(0)
s_waitcnt lgkmcnt(15)
v_add_f32 v20, v20, v24
v_add_f32 v28, v28, v32
v_add_f32 v20, v20, v28
v_add_f32 v21, v21, v25
v_add_f32 v29, v29, v33
v_add_f32 v21, v21, v29
v_add_f32 v22, v22, v26
v_add_f32 v30, v30, v34
v_add_f32 v22, v22, v30
v_add_f32 v23, v23, v27
v_add_f32 v31, v31, v35
v_add_f32 v23, v23, v31
v_lshlrev_b32 v3, 16, v128
v_and_b32 v4, 0xffff0000, v128
v_lshlrev_b32 v5, 16, v129
v_and_b32 v6, 0xffff0000, v129
v_add_f32 v20, v20, v3
v_add_f32 v21, v21, v4
v_add_f32 v22, v22, v5
v_add_f32 v23, v23, v6
v_cvt_pk_bf16_f32 v24, v20, v21
v_cvt_pk_bf16_f32 v25, v22, v23
buffer_store_dwordx2 v[24:25], v169, s[12:15], s58 offen
s_waitcnt lgkmcnt(12)
v_add_f32 v36, v36, v40
v_add_f32 v44, v44, v48
v_add_f32 v36, v36, v44
v_add_f32 v37, v37, v41
v_add_f32 v45, v45, v49
v_add_f32 v37, v37, v45
v_add_f32 v38, v38, v42
v_add_f32 v46, v46, v50
v_add_f32 v38, v38, v46
v_add_f32 v39, v39, v43
v_add_f32 v47, v47, v51
v_add_f32 v39, v39, v47
v_lshlrev_b32 v3, 16, v130
v_and_b32 v4, 0xffff0000, v130
v_lshlrev_b32 v5, 16, v131
v_and_b32 v6, 0xffff0000, v131
v_add_f32 v36, v36, v3
v_add_f32 v37, v37, v4
v_add_f32 v38, v38, v5
v_add_f32 v39, v39, v6
v_cvt_pk_bf16_f32 v40, v36, v37
v_cvt_pk_bf16_f32 v41, v38, v39
buffer_store_dwordx2 v[40:41], v170, s[12:15], s58 offen
s_waitcnt lgkmcnt(8)
v_add_f32 v52, v52, v56
v_add_f32 v60, v60, v64
v_add_f32 v52, v52, v60
v_add_f32 v53, v53, v57
v_add_f32 v61, v61, v65
v_add_f32 v53, v53, v61
v_add_f32 v54, v54, v58
v_add_f32 v62, v62, v66
v_add_f32 v54, v54, v62
v_add_f32 v55, v55, v59
v_add_f32 v63, v63, v67
v_add_f32 v55, v55, v63
v_lshlrev_b32 v3, 16, v132
v_and_b32 v4, 0xffff0000, v132
v_lshlrev_b32 v5, 16, v133
v_and_b32 v6, 0xffff0000, v133
v_add_f32 v52, v52, v3
v_add_f32 v53, v53, v4
v_add_f32 v54, v54, v5
v_add_f32 v55, v55, v6
v_cvt_pk_bf16_f32 v56, v52, v53
v_cvt_pk_bf16_f32 v57, v54, v55
buffer_store_dwordx2 v[56:57], v171, s[12:15], s58 offen
s_waitcnt lgkmcnt(4)
v_add_f32 v68, v68, v72
v_add_f32 v76, v76, v80
v_add_f32 v68, v68, v76
v_add_f32 v69, v69, v73
v_add_f32 v77, v77, v81
v_add_f32 v69, v69, v77
v_add_f32 v70, v70, v74
v_add_f32 v78, v78, v82
v_add_f32 v70, v70, v78
v_add_f32 v71, v71, v75
v_add_f32 v79, v79, v83
v_add_f32 v71, v71, v79
v_lshlrev_b32 v3, 16, v134
v_and_b32 v4, 0xffff0000, v134
v_lshlrev_b32 v5, 16, v135
v_and_b32 v6, 0xffff0000, v135
v_add_f32 v68, v68, v3
v_add_f32 v69, v69, v4
v_add_f32 v70, v70, v5
v_add_f32 v71, v71, v6
v_cvt_pk_bf16_f32 v72, v68, v69
v_cvt_pk_bf16_f32 v73, v70, v71
buffer_store_dwordx2 v[72:73], v172, s[12:15], s58 offen
s_waitcnt lgkmcnt(0)
v_add_f32 v84, v84, v88
v_add_f32 v92, v92, v96
v_add_f32 v84, v84, v92
v_add_f32 v85, v85, v89
v_add_f32 v93, v93, v97
v_add_f32 v85, v85, v93
v_add_f32 v86, v86, v90
v_add_f32 v94, v94, v98
v_add_f32 v86, v86, v94
v_add_f32 v87, v87, v91
v_add_f32 v95, v95, v99
v_add_f32 v87, v87, v95
v_lshlrev_b32 v3, 16, v136
v_and_b32 v4, 0xffff0000, v136
v_lshlrev_b32 v5, 16, v137
v_and_b32 v6, 0xffff0000, v137
v_add_f32 v84, v84, v3
v_add_f32 v85, v85, v4
v_add_f32 v86, v86, v5
v_add_f32 v87, v87, v6
v_cvt_pk_bf16_f32 v88, v84, v85
v_cvt_pk_bf16_f32 v89, v86, v87
buffer_store_dwordx2 v[88:89], v173, s[12:15], s58 offen
s_endpgm
K2_COL:
s_and_b32 s52, s40, 1
s_add_u32 s44, s2, 1
s_cmp_lt_u32 s40, 6
s_cbranch_scc1 P2_COLN
s_lshl_b32 s54, s42, 3
s_add_u32 s54, s54, s41
s_cmp_lt_u32 s54, 192
s_cbranch_scc1 K2_END
s_add_u32 s44, s54, 105
s_cmp_ge_u32 s54, 216
s_cselect_b32 s55, 64, 0
s_sub_u32 s44, s44, s55
P2_COLN:
s_cmp_eq_u32 s44, 320
s_cselect_b32 s45, 1, 0
s_cselect_b32 s46, 0, s44
s_cmp_eq_u32 s46, 0
s_cselect_b32 s30, 0, s30
s_lshl_b32 s47, s46, 13
s_add_u32 s47, s47, 9437184
s_lshl_b32 s54, s52, 11
s_add_u32 s47, s47, s54
s_lshl_b32 s54, s45, 12
s_add_u32 s48, s47, s54
s_add_u32 s47, s47, 4096
s_lshl_b32 s49, s44, 13
s_add_u32 s49, s49, 12582912
s_lshl_b32 s54, s52, 12
s_add_u32 s49, s49, s54
s_lshl_b32 s50, s46, 1
s_add_u32 s50, s50, s45
s_lshl_b32 s50, s50, 12
s_add_u32 s50, s50, 19922944
s_lshl_b32 s54, s52, 6
s_add_u32 s50, s50, s54
s_add_u32 s51, s50, 4096
v_lshlrev_b32 v4, 4, v1
s_cmp_lg_u32 s40, 4
s_cbranch_scc1 P2_CW1
s_and_b32 s43, s2, 7
s_lshl_b32 s43, s43, 7
s_add_u32 s43, s43, 311296
v_mov_b32 v3, 0
v_mov_b32 v8, 40
s_mov_b32 s55, 0
P2_PAT:
buffer_load_dword v9, v3, s[16:19], s43 offen sc1
s_add_u32 s55, s55, 1
s_waitcnt vmcnt(0)
v_cmp_ne_u32 vcc, v8, v9
s_cmp_ge_u32 s55, 100000
s_cbranch_scc1 P2_PATD
s_cbranch_vccz P2_PATD
s_sleep 3
s_branch P2_PAT
P2_PATD:
v_mov_b32 v5, 63504
s_mov_b32 s55, 0
P2_LWD4:
ds_read_b32 v6, v5
s_add_u32 s55, s55, 1
s_waitcnt lgkmcnt(0)
v_readfirstlane_b32 s56, v6
s_cmp_ge_u32 s55, 2000000
s_cbranch_scc1 P2_LWD4D
s_cmp_lg_u32 s56, 0
s_cbranch_scc1 P2_LWD4D
s_sleep 1
s_branch P2_LWD4
P2_LWD4D:
v_mov_b32 v5, 63512
v_mov_b32 v6, 1
ds_write_b32 v5, v6
s_branch P2_CW2
P2_CW1:
v_mov_b32 v5, 63512
s_mov_b32 s55, 0
P2_LAT:
ds_read_b32 v6, v5
s_add_u32 s55, s55, 1
s_waitcnt lgkmcnt(0)
v_readfirstlane_b32 s56, v6
s_cmp_ge_u32 s55, 2000000
s_cbranch_scc1 P2_LATD
s_cmp_lg_u32 s56, 0
s_cbranch_scc1 P2_LATD
s_sleep 1
s_branch P2_LAT
P2_LATD:
P2_CW2:
s_setprio 3
buffer_load_dwordx4 v[20:23], v4, s[16:19], s48 offen offset:0 sc1
buffer_load_dwordx4 v[28:31], v4, s[28:31], s47 offen offset:0 sc1
buffer_load_dwordx4 v[24:27], v4, s[16:19], s48 offen offset:1024 sc1
buffer_load_dwordx4 v[32:35], v4, s[28:31], s47 offen offset:1024 sc1
buffer_load_dwordx4 v[52:55], v4, s[16:19], s49 offen offset:0 sc1
buffer_load_dwordx4 v[56:59], v4, s[16:19], s49 offen offset:1024 sc1
buffer_load_dwordx4 v[60:63], v4, s[16:19], s49 offen offset:2048 sc1
buffer_load_dwordx4 v[64:67], v4, s[16:19], s49 offen offset:3072 sc1
s_lshl_b32 s54, s52, 13
v_add_u32 v10, s54, v4
s_sub_u32 s54, s40, 4
s_lshl_b32 s55, s54, 13
s_add_u32 s55, s55, 63616
v_add_u32 v11, s55, v4
s_xor_b32 s56, s54, 1
s_lshl_b32 s55, s56, 13
s_add_u32 s55, s55, 63616
v_add_u32 v12, s55, v4
s_lshl_b32 s54, s54, 2
s_add_u32 s54, s54, 63488
v_mov_b32 v15, s54
s_lshl_b32 s56, s56, 2
s_add_u32 s56, s56, 63488
v_mov_b32 v16, s56
s_mul_i32 s54, s52, 6144
s_add_u32 s54, s54, 32768
v_add_u32 v13, s54, v4
s_lshl_b32 s54, s52, 11
s_add_u32 s54, s54, 34816
v_add_u32 v14, s54, v4
ds_read_b128 v[84:87], v4 offset:57344
ds_read_b128 v[92:95], v4 offset:59392
ds_read_b128 v[100:103], v4 offset:61440
ds_read_b128 v[88:91], v4 offset:58368
ds_read_b128 v[96:99], v4 offset:60416
ds_read_b128 v[104:107], v4 offset:62464
s_waitcnt lgkmcnt(0)
s_waitcnt vmcnt(4)
v_mfma_f32_32x32x16_bf16 v[128:143], v[20:23], v[84:87], 0
v_mfma_f32_32x32x16_bf16 v[144:159], v[20:23], v[92:95], 0
v_mfma_f32_32x32x16_bf16 v[128:143], v[28:31], v[100:103], v[128:143]
v_mfma_f32_32x32x16_bf16 v[144:159], v[28:31], v[84:87], v[144:159]
v_mfma_f32_32x32x16_bf16 v[128:143], v[24:27], v[88:91], v[128:143]
v_mfma_f32_32x32x16_bf16 v[144:159], v[24:27], v[96:99], v[144:159]
v_mfma_f32_32x32x16_bf16 v[128:143], v[32:35], v[104:107], v[128:143]
v_mfma_f32_32x32x16_bf16 v[144:159], v[32:35], v[88:91], v[144:159]
ds_read_b128 v[108:111], v10 offset:0
ds_read_b128 v[112:115], v10 offset:1024
ds_read_b128 v[116:119], v10 offset:2048
ds_read_b128 v[120:123], v10 offset:3072
s_waitcnt lgkmcnt(2)
s_nop 5
v_mul_f32 v224, v128, v108
v_mul_f32 v228, v144, v108
v_fmac_f32 v224, v144, v112
v_fma_f32 v228, -v128, v112, v228
v_mul_f32 v225, v129, v109
v_mul_f32 v229, v145, v109
v_fmac_f32 v225, v145, v113
v_fma_f32 v229, -v129, v113, v229
v_mul_f32 v226, v130, v110
v_mul_f32 v230, v146, v110
v_fmac_f32 v226, v146, v114
v_fma_f32 v230, -v130, v114, v230
v_mul_f32 v227, v131, v111
v_mul_f32 v231, v147, v111
v_fmac_f32 v227, v147, v115
v_fma_f32 v231, -v131, v115, v231
v_cvt_pk_bf16_f32 v20, v224, v225
v_cvt_pk_bf16_f32 v21, v226, v227
v_cvt_pk_bf16_f32 v28, v228, v229
v_cvt_pk_bf16_f32 v29, v230, v231
ds_read_b128 v[108:111], v10 offset:4096
ds_read_b128 v[112:115], v10 offset:5120
s_waitcnt lgkmcnt(2)
v_mul_f32 v224, v132, v116
v_mul_f32 v228, v148, v116
v_fmac_f32 v224, v148, v120
v_fma_f32 v228, -v132, v120, v228
v_mul_f32 v225, v133, v117
v_mul_f32 v229, v149, v117
v_fmac_f32 v225, v149, v121
v_fma_f32 v229, -v133, v121, v229
v_mul_f32 v226, v134, v118
v_mul_f32 v230, v150, v118
v_fmac_f32 v226, v150, v122
v_fma_f32 v230, -v134, v122, v230
v_mul_f32 v227, v135, v119
v_mul_f32 v231, v151, v119
v_fmac_f32 v227, v151, v123
v_fma_f32 v231, -v135, v123, v231
v_cvt_pk_bf16_f32 v22, v224, v225
v_cvt_pk_bf16_f32 v23, v226, v227
v_cvt_pk_bf16_f32 v30, v228, v229
v_cvt_pk_bf16_f32 v31, v230, v231
ds_read_b128 v[116:119], v10 offset:6144
ds_read_b128 v[120:123], v10 offset:7168
s_waitcnt lgkmcnt(2)
v_mul_f32 v224, v136, v108
v_mul_f32 v228, v152, v108
v_fmac_f32 v224, v152, v112
v_fma_f32 v228, -v136, v112, v228
v_mul_f32 v225, v137, v109
v_mul_f32 v229, v153, v109
v_fmac_f32 v225, v153, v113
v_fma_f32 v229, -v137, v113, v229
v_mul_f32 v226, v138, v110
v_mul_f32 v230, v154, v110
v_fmac_f32 v226, v154, v114
v_fma_f32 v230, -v138, v114, v230
v_mul_f32 v227, v139, v111
v_mul_f32 v231, v155, v111
v_fmac_f32 v227, v155, v115
v_fma_f32 v231, -v139, v115, v231
v_cvt_pk_bf16_f32 v24, v224, v225
v_cvt_pk_bf16_f32 v25, v226, v227
v_cvt_pk_bf16_f32 v32, v228, v229
v_cvt_pk_bf16_f32 v33, v230, v231
s_waitcnt lgkmcnt(0)
v_mul_f32 v224, v140, v116
v_mul_f32 v228, v156, v116
v_fmac_f32 v224, v156, v120
v_fma_f32 v228, -v140, v120, v228
v_mul_f32 v225, v141, v117
v_mul_f32 v229, v157, v117
v_fmac_f32 v225, v157, v121
v_fma_f32 v229, -v141, v121, v229
v_mul_f32 v226, v142, v118
v_mul_f32 v230, v158, v118
v_fmac_f32 v226, v158, v122
v_fma_f32 v230, -v142, v122, v230
v_mul_f32 v227, v143, v119
v_mul_f32 v231, v159, v119
v_fmac_f32 v227, v159, v123
v_fma_f32 v231, -v143, v123, v231
v_cvt_pk_bf16_f32 v26, v224, v225
v_cvt_pk_bf16_f32 v27, v226, v227
v_cvt_pk_bf16_f32 v34, v228, v229
v_cvt_pk_bf16_f32 v35, v230, v231
ds_read_b128 v[192:195], v13 offset:0
ds_read_b128 v[196:199], v13 offset:8192
ds_read_b128 v[200:203], v13 offset:16384
ds_write_b128 v11, v[20:23] offset:0
ds_write_b128 v11, v[24:27] offset:1024
ds_write_b128 v11, v[28:31] offset:2048
ds_write_b128 v11, v[32:35] offset:3072
v_mov_b32 v5, 1
s_waitcnt lgkmcnt(0)
ds_write_b32 v15, v5
s_mov_b32 s55, 0
K2_EX1:
ds_read_b32 v6, v16
s_add_u32 s55, s55, 1
s_waitcnt lgkmcnt(0)
v_readfirstlane_b32 s56, v6
s_cmp_ge_u32 s55, 1000000
s_cbranch_scc1 K2_EXD1
s_cmp_lt_u32 s56, 1
s_cbranch_scc1 K2_EX1
K2_EXD1:
ds_read_b128 v[36:39], v12 offset:0
ds_read_b128 v[40:43], v12 offset:1024
ds_read_b128 v[44:47], v12 offset:2048
ds_read_b128 v[48:51], v12 offset:3072
ds_read_b128 v[204:207], v13 offset:1024
ds_read_b128 v[208:211], v13 offset:9216
ds_read_b128 v[212:215], v13 offset:17408
v_mfma_f32_32x32x16_bf16 v[128:143], v[192:195], v[20:23], 0
v_mfma_f32_32x32x16_bf16 v[144:159], v[196:199], v[20:23], 0
v_mfma_f32_32x32x16_bf16 v[128:143], v[200:203], v[28:31], v[128:143]
v_mfma_f32_32x32x16_bf16 v[144:159], v[192:195], v[28:31], v[144:159]
ds_read_b128 v[192:195], v14 offset:0
ds_read_b128 v[196:199], v14 offset:8192
ds_read_b128 v[200:203], v14 offset:16384
s_waitcnt lgkmcnt(3)
v_mfma_f32_32x32x16_bf16 v[128:143], v[204:207], v[24:27], v[128:143]
v_mfma_f32_32x32x16_bf16 v[144:159], v[208:211], v[24:27], v[144:159]
v_mfma_f32_32x32x16_bf16 v[128:143], v[212:215], v[32:35], v[128:143]
v_mfma_f32_32x32x16_bf16 v[144:159], v[204:207], v[32:35], v[144:159]
ds_read_b128 v[204:207], v14 offset:1024
ds_read_b128 v[208:211], v14 offset:9216
ds_read_b128 v[212:215], v14 offset:17408
s_waitcnt lgkmcnt(3)
v_mfma_f32_32x32x16_bf16 v[128:143], v[192:195], v[36:39], v[128:143]
v_mfma_f32_32x32x16_bf16 v[144:159], v[196:199], v[36:39], v[144:159]
v_mfma_f32_32x32x16_bf16 v[128:143], v[200:203], v[44:47], v[128:143]
v_mfma_f32_32x32x16_bf16 v[144:159], v[192:195], v[44:47], v[144:159]
s_waitcnt lgkmcnt(0)
v_mfma_f32_32x32x16_bf16 v[128:143], v[204:207], v[40:43], v[128:143]
v_mfma_f32_32x32x16_bf16 v[144:159], v[208:211], v[40:43], v[144:159]
v_mfma_f32_32x32x16_bf16 v[128:143], v[212:215], v[48:51], v[128:143]
v_mfma_f32_32x32x16_bf16 v[144:159], v[204:207], v[48:51], v[144:159]
s_waitcnt vmcnt(0)
v_lshlrev_b32 v6, 16, v52
v_and_b32 v7, 0xffff0000, v52
s_nop 7
v_mul_f32 v224, v128, v6
v_mul_f32 v228, v144, v6
v_fma_f32 v224, -v144, v7, v224
v_fmac_f32 v228, v128, v7
v_lshlrev_b32 v6, 16, v53
v_and_b32 v7, 0xffff0000, v53
v_mul_f32 v225, v129, v6
v_mul_f32 v229, v145, v6
v_fma_f32 v225, -v145, v7, v225
v_fmac_f32 v229, v129, v7
v_lshlrev_b32 v6, 16, v54
v_and_b32 v7, 0xffff0000, v54
v_mul_f32 v226, v130, v6
v_mul_f32 v230, v146, v6
v_fma_f32 v226, -v146, v7, v226
v_fmac_f32 v230, v130, v7
v_lshlrev_b32 v6, 16, v55
v_and_b32 v7, 0xffff0000, v55
v_mul_f32 v227, v131, v6
v_mul_f32 v231, v147, v6
v_fma_f32 v227, -v147, v7, v227
v_fmac_f32 v231, v131, v7
v_cvt_pk_bf16_f32 v20, v224, v225
v_cvt_pk_bf16_f32 v21, v226, v227
v_cvt_pk_bf16_f32 v28, v228, v229
v_cvt_pk_bf16_f32 v29, v230, v231
v_lshlrev_b32 v6, 16, v56
v_and_b32 v7, 0xffff0000, v56
v_mul_f32 v224, v132, v6
v_mul_f32 v228, v148, v6
v_fma_f32 v224, -v148, v7, v224
v_fmac_f32 v228, v132, v7
v_lshlrev_b32 v6, 16, v57
v_and_b32 v7, 0xffff0000, v57
v_mul_f32 v225, v133, v6
v_mul_f32 v229, v149, v6
v_fma_f32 v225, -v149, v7, v225
v_fmac_f32 v229, v133, v7
v_lshlrev_b32 v6, 16, v58
v_and_b32 v7, 0xffff0000, v58
v_mul_f32 v226, v134, v6
v_mul_f32 v230, v150, v6
v_fma_f32 v226, -v150, v7, v226
v_fmac_f32 v230, v134, v7
v_lshlrev_b32 v6, 16, v59
v_and_b32 v7, 0xffff0000, v59
v_mul_f32 v227, v135, v6
v_mul_f32 v231, v151, v6
v_fma_f32 v227, -v151, v7, v227
v_fmac_f32 v231, v135, v7
v_cvt_pk_bf16_f32 v22, v224, v225
v_cvt_pk_bf16_f32 v23, v226, v227
v_cvt_pk_bf16_f32 v30, v228, v229
v_cvt_pk_bf16_f32 v31, v230, v231
v_lshlrev_b32 v6, 16, v60
v_and_b32 v7, 0xffff0000, v60
v_mul_f32 v224, v136, v6
v_mul_f32 v228, v152, v6
v_fma_f32 v224, -v152, v7, v224
v_fmac_f32 v228, v136, v7
v_lshlrev_b32 v6, 16, v61
v_and_b32 v7, 0xffff0000, v61
v_mul_f32 v225, v137, v6
v_mul_f32 v229, v153, v6
v_fma_f32 v225, -v153, v7, v225
v_fmac_f32 v229, v137, v7
v_lshlrev_b32 v6, 16, v62
v_and_b32 v7, 0xffff0000, v62
v_mul_f32 v226, v138, v6
v_mul_f32 v230, v154, v6
v_fma_f32 v226, -v154, v7, v226
v_fmac_f32 v230, v138, v7
v_lshlrev_b32 v6, 16, v63
v_and_b32 v7, 0xffff0000, v63
v_mul_f32 v227, v139, v6
v_mul_f32 v231, v155, v6
v_fma_f32 v227, -v155, v7, v227
v_fmac_f32 v231, v139, v7
v_cvt_pk_bf16_f32 v24, v224, v225
v_cvt_pk_bf16_f32 v25, v226, v227
v_cvt_pk_bf16_f32 v32, v228, v229
v_cvt_pk_bf16_f32 v33, v230, v231
v_lshlrev_b32 v6, 16, v64
v_and_b32 v7, 0xffff0000, v64
v_mul_f32 v224, v140, v6
v_mul_f32 v228, v156, v6
v_fma_f32 v224, -v156, v7, v224
v_fmac_f32 v228, v140, v7
v_lshlrev_b32 v6, 16, v65
v_and_b32 v7, 0xffff0000, v65
v_mul_f32 v225, v141, v6
v_mul_f32 v229, v157, v6
v_fma_f32 v225, -v157, v7, v225
v_fmac_f32 v229, v141, v7
v_lshlrev_b32 v6, 16, v66
v_and_b32 v7, 0xffff0000, v66
v_mul_f32 v226, v142, v6
v_mul_f32 v230, v158, v6
v_fma_f32 v226, -v158, v7, v226
v_fmac_f32 v230, v142, v7
v_lshlrev_b32 v6, 16, v67
v_and_b32 v7, 0xffff0000, v67
v_mul_f32 v227, v143, v6
v_mul_f32 v231, v159, v6
v_fma_f32 v227, -v159, v7, v227
v_fmac_f32 v231, v143, v7
v_cvt_pk_bf16_f32 v26, v224, v225
v_cvt_pk_bf16_f32 v27, v226, v227
v_cvt_pk_bf16_f32 v34, v228, v229
v_cvt_pk_bf16_f32 v35, v230, v231
ds_read_b128 v[192:195], v13 offset:0
ds_read_b128 v[196:199], v13 offset:8192
ds_read_b128 v[200:203], v13 offset:16384
ds_write_b128 v11, v[20:23] offset:4096
ds_write_b128 v11, v[24:27] offset:5120
ds_write_b128 v11, v[28:31] offset:6144
ds_write_b128 v11, v[32:35] offset:7168
v_mov_b32 v5, 2
s_waitcnt lgkmcnt(0)
ds_write_b32 v15, v5
s_mov_b32 s55, 0
K2_EX2:
ds_read_b32 v6, v16
s_add_u32 s55, s55, 1
s_waitcnt lgkmcnt(0)
v_readfirstlane_b32 s56, v6
s_cmp_ge_u32 s55, 1000000
s_cbranch_scc1 K2_EXD2
s_cmp_lt_u32 s56, 2
s_cbranch_scc1 K2_EX2
K2_EXD2:
ds_read_b128 v[36:39], v12 offset:4096
ds_read_b128 v[40:43], v12 offset:5120
ds_read_b128 v[44:47], v12 offset:6144
ds_read_b128 v[48:51], v12 offset:7168
ds_read_b128 v[204:207], v13 offset:1024
ds_read_b128 v[208:211], v13 offset:9216
ds_read_b128 v[212:215], v13 offset:17408
v_mfma_f32_32x32x16_bf16 v[128:143], v[20:23], v[192:195], 0
v_mfma_f32_32x32x16_bf16 v[144:159], v[28:31], v[192:195], 0
v_mfma_f32_32x32x16_bf16 v[128:143], v[28:31], v[196:199], v[128:143]
v_mfma_f32_32x32x16_bf16 v[144:159], v[20:23], v[200:203], v[144:159]
ds_read_b128 v[192:195], v14 offset:0
ds_read_b128 v[196:199], v14 offset:8192
ds_read_b128 v[200:203], v14 offset:16384
s_waitcnt lgkmcnt(3)
v_mfma_f32_32x32x16_bf16 v[128:143], v[24:27], v[204:207], v[128:143]
v_mfma_f32_32x32x16_bf16 v[144:159], v[32:35], v[204:207], v[144:159]
v_mfma_f32_32x32x16_bf16 v[128:143], v[32:35], v[208:211], v[128:143]
v_mfma_f32_32x32x16_bf16 v[144:159], v[24:27], v[212:215], v[144:159]
ds_read_b128 v[204:207], v14 offset:1024
ds_read_b128 v[208:211], v14 offset:9216
ds_read_b128 v[212:215], v14 offset:17408
s_waitcnt lgkmcnt(3)
v_mfma_f32_32x32x16_bf16 v[128:143], v[36:39], v[192:195], v[128:143]
v_mfma_f32_32x32x16_bf16 v[144:159], v[44:47], v[192:195], v[144:159]
v_mfma_f32_32x32x16_bf16 v[128:143], v[44:47], v[196:199], v[128:143]
v_mfma_f32_32x32x16_bf16 v[144:159], v[36:39], v[200:203], v[144:159]
s_waitcnt lgkmcnt(0)
v_mfma_f32_32x32x16_bf16 v[128:143], v[40:43], v[204:207], v[128:143]
v_mfma_f32_32x32x16_bf16 v[144:159], v[48:51], v[204:207], v[144:159]
v_mfma_f32_32x32x16_bf16 v[128:143], v[48:51], v[208:211], v[128:143]
v_mfma_f32_32x32x16_bf16 v[144:159], v[40:43], v[212:215], v[144:159]
ds_read_b128 v[108:111], v10 offset:16384
ds_read_b128 v[112:115], v10 offset:17408
ds_read_b128 v[116:119], v10 offset:18432
ds_read_b128 v[120:123], v10 offset:19456
s_waitcnt lgkmcnt(2)
s_nop 5
v_mul_f32 v224, v128, v108
v_mul_f32 v228, v144, v108
v_fma_f32 v224, -v144, v112, v224
v_fmac_f32 v228, v128, v112
v_mul_f32 v225, v129, v109
v_mul_f32 v229, v145, v109
v_fma_f32 v225, -v145, v113, v225
v_fmac_f32 v229, v129, v113
v_mul_f32 v226, v130, v110
v_mul_f32 v230, v146, v110
v_fma_f32 v226, -v146, v114, v226
v_fmac_f32 v230, v130, v114
v_mul_f32 v227, v131, v111
v_mul_f32 v231, v147, v111
v_fma_f32 v227, -v147, v115, v227
v_fmac_f32 v231, v131, v115
v_cvt_pk_bf16_f32 v20, v224, v225
v_cvt_pk_bf16_f32 v21, v226, v227
v_cvt_pk_bf16_f32 v28, v228, v229
v_cvt_pk_bf16_f32 v29, v230, v231
ds_read_b128 v[108:111], v10 offset:20480
ds_read_b128 v[112:115], v10 offset:21504
s_waitcnt lgkmcnt(2)
v_mul_f32 v224, v132, v116
v_mul_f32 v228, v148, v116
v_fma_f32 v224, -v148, v120, v224
v_fmac_f32 v228, v132, v120
v_mul_f32 v225, v133, v117
v_mul_f32 v229, v149, v117
v_fma_f32 v225, -v149, v121, v225
v_fmac_f32 v229, v133, v121
v_mul_f32 v226, v134, v118
v_mul_f32 v230, v150, v118
v_fma_f32 v226, -v150, v122, v226
v_fmac_f32 v230, v134, v122
v_mul_f32 v227, v135, v119
v_mul_f32 v231, v151, v119
v_fma_f32 v227, -v151, v123, v227
v_fmac_f32 v231, v135, v123
v_cvt_pk_bf16_f32 v22, v224, v225
v_cvt_pk_bf16_f32 v23, v226, v227
v_cvt_pk_bf16_f32 v30, v228, v229
v_cvt_pk_bf16_f32 v31, v230, v231
ds_read_b128 v[116:119], v10 offset:22528
ds_read_b128 v[120:123], v10 offset:23552
s_waitcnt lgkmcnt(2)
v_mul_f32 v224, v136, v108
v_mul_f32 v228, v152, v108
v_fma_f32 v224, -v152, v112, v224
v_fmac_f32 v228, v136, v112
v_mul_f32 v225, v137, v109
v_mul_f32 v229, v153, v109
v_fma_f32 v225, -v153, v113, v225
v_fmac_f32 v229, v137, v113
v_mul_f32 v226, v138, v110
v_mul_f32 v230, v154, v110
v_fma_f32 v226, -v154, v114, v226
v_fmac_f32 v230, v138, v114
v_mul_f32 v227, v139, v111
v_mul_f32 v231, v155, v111
v_fma_f32 v227, -v155, v115, v227
v_fmac_f32 v231, v139, v115
v_cvt_pk_bf16_f32 v24, v224, v225
v_cvt_pk_bf16_f32 v25, v226, v227
v_cvt_pk_bf16_f32 v32, v228, v229
v_cvt_pk_bf16_f32 v33, v230, v231
s_waitcnt lgkmcnt(0)
v_mul_f32 v224, v140, v116
v_mul_f32 v228, v156, v116
v_fma_f32 v224, -v156, v120, v224
v_fmac_f32 v228, v140, v120
v_mul_f32 v225, v141, v117
v_mul_f32 v229, v157, v117
v_fma_f32 v225, -v157, v121, v225
v_fmac_f32 v229, v141, v121
v_mul_f32 v226, v142, v118
v_mul_f32 v230, v158, v118
v_fma_f32 v226, -v158, v122, v226
v_fmac_f32 v230, v142, v122
v_mul_f32 v227, v143, v119
v_mul_f32 v231, v159, v119
v_fma_f32 v227, -v159, v123, v227
v_fmac_f32 v231, v143, v123
v_cvt_pk_bf16_f32 v26, v224, v225
v_cvt_pk_bf16_f32 v27, v226, v227
v_cvt_pk_bf16_f32 v34, v228, v229
v_cvt_pk_bf16_f32 v35, v230, v231
v_mfma_f32_32x32x16_bf16 v[128:143], v[20:23], v[84:87], 0
v_mfma_f32_32x32x16_bf16 v[144:159], v[28:31], v[84:87], 0
v_mfma_f32_32x32x16_bf16 v[128:143], v[28:31], v[92:95], v[128:143]
v_mfma_f32_32x32x16_bf16 v[144:159], v[20:23], v[100:103], v[144:159]
v_mfma_f32_32x32x16_bf16 v[128:143], v[24:27], v[88:91], v[128:143]
v_mfma_f32_32x32x16_bf16 v[144:159], v[32:35], v[88:91], v[144:159]
v_mfma_f32_32x32x16_bf16 v[128:143], v[32:35], v[96:99], v[128:143]
v_mfma_f32_32x32x16_bf16 v[144:159], v[24:27], v[104:107], v[144:159]
s_sub_u32 s54, s40, 4
s_mul_i32 s54, s54, 5120
s_add_u32 s54, s54, 96384
v_and_b32 v6, 31, v1
v_mul_u32_u24 v6, 80, v6
v_lshrrev_b32 v7, 5, v1
v_lshl_add_u32 v6, v7, 3, v6
v_add_u32 v6, s54, v6
v_lshrrev_b32 v7, 2, v1
v_mul_u32_u24 v8, 80, v7
v_and_b32 v9, 3, v1
v_lshl_add_u32 v8, v9, 4, v8
v_add_u32 v8, s54, v8
v_lshlrev_b32 v7, 7, v7
v_lshl_add_u32 v7, v9, 4, v7
v_cvt_pk_bf16_f32 v224, v128, v129
v_cvt_pk_bf16_f32 v225, v130, v131
ds_write_b64 v6, v[224:225] offset:0
v_cvt_pk_bf16_f32 v226, v132, v133
v_cvt_pk_bf16_f32 v227, v134, v135
ds_write_b64 v6, v[226:227] offset:16
v_cvt_pk_bf16_f32 v224, v136, v137
v_cvt_pk_bf16_f32 v225, v138, v139
ds_write_b64 v6, v[224:225] offset:32
v_cvt_pk_bf16_f32 v226, v140, v141
v_cvt_pk_bf16_f32 v227, v142, v143
ds_write_b64 v6, v[226:227] offset:48
v_cvt_pk_bf16_f32 v228, v144, v145
v_cvt_pk_bf16_f32 v229, v146, v147
ds_write_b64 v6, v[228:229] offset:2560
v_cvt_pk_bf16_f32 v230, v148, v149
v_cvt_pk_bf16_f32 v231, v150, v151
ds_write_b64 v6, v[230:231] offset:2576
v_cvt_pk_bf16_f32 v228, v152, v153
v_cvt_pk_bf16_f32 v229, v154, v155
ds_write_b64 v6, v[228:229] offset:2592
v_cvt_pk_bf16_f32 v230, v156, v157
v_cvt_pk_bf16_f32 v231, v158, v159
ds_write_b64 v6, v[230:231] offset:2608
s_waitcnt lgkmcnt(0)
ds_read_b128 v[20:23], v8 offset:0
ds_read_b128 v[24:27], v8 offset:1280
ds_read_b128 v[28:31], v8 offset:2560
ds_read_b128 v[32:35], v8 offset:3840
s_waitcnt lgkmcnt(3)
buffer_store_dwordx4 v[20:23], v7, s[16:19], s50 offen offset:0 sc1
s_waitcnt lgkmcnt(2)
buffer_store_dwordx4 v[24:27], v7, s[16:19], s50 offen offset:2048 sc1
s_waitcnt lgkmcnt(1)
buffer_store_dwordx4 v[28:31], v7, s[28:31], s51 offen offset:0 sc1
s_waitcnt lgkmcnt(0)
buffer_store_dwordx4 v[32:35], v7, s[28:31], s51 offen offset:2048 sc1
s_waitcnt vmcnt(0)
v_mov_b32 v5, 3
ds_write_b32 v15, v5
s_cmp_eq_u32 s52, 1
s_cbranch_scc1 K2_COLX
s_mov_b32 s55, 0
K2_EX3:
ds_read_b32 v6, v16
s_add_u32 s55, s55, 1
s_waitcnt lgkmcnt(0)
v_readfirstlane_b32 s56, v6
s_cmp_ge_u32 s55, 1000000
s_cbranch_scc1 K2_EXD3
s_cmp_lt_u32 s56, 3
s_cbranch_scc1 K2_EX3
K2_EXD3:
s_and_b32 s54, s44, 7
s_lshl_b32 s54, s54, 7
s_add_u32 s54, s54, 262144
v_mov_b32 v5, 1
v_lshlrev_b32 v6, 10, v1
s_mov_b32 exec_hi, 0
buffer_atomic_add v5, v6, s[16:19], s54 offen
s_mov_b64 exec, -1
K2_COLX:
s_endpgm
K2_END:
s_endpgm
K_END:
s_endpgm
.section .rodata,"a"
.p2align 6
.amdhsa_kernel parallel_sum__spectral_gfnet__glu_gated_bilinear__prompt_kernel
  .amdhsa_next_free_vgpr 256
  .amdhsa_next_free_sgpr 102
  .amdhsa_accum_offset 256
  .amdhsa_group_segment_fixed_size 0
  .amdhsa_kernarg_size 80
  .amdhsa_user_sgpr_count 2
  .amdhsa_user_sgpr_kernarg_segment_ptr 1
  .amdhsa_system_sgpr_workgroup_id_x 1
  .amdhsa_float_denorm_mode_32 3
.end_amdhsa_kernel
```
